```python
import torch

def _softmax(x, axis=-1):
    return torch.softmax(x, dim=axis)
def _gelu(x):
    return torch.nn.functional.gelu(x, approximate="tanh")
def _silu(x):
    return torch.nn.functional.silu(x)
def _sigmoid(x):
    return torch.sigmoid(x)
def _layernorm(x, axis=-1, eps=1e-5):
    m = x.mean(dim=axis, keepdim=True)
    v = x.var(dim=axis, keepdim=True, unbiased=False)
    return (x - m) / torch.sqrt(v + eps)
def _scatter_add(tgt, idx, src, axis=0):
    return tgt.clone().index_add_(axis, idx, src)
def _segment_sum(src, seg, n):
    out = torch.zeros((n,) + src.shape[1:], dtype=src.dtype)
    return out.index_add_(0, seg, src)
def _pad(x, pw):
    flat = tuple(v for pair in reversed(pw) for v in pair)
    return torch.nn.functional.pad(x, flat)

kernel_name = 'standalone__mha_block_cached__near_ridge'

def setup_inputs():

    _w = (lambda a: (lambda t: t.to(torch.bfloat16) if t.is_floating_point() else t)(torch.as_tensor(a)))
    B, Sq, D = 32, 144, 512
    H, Sk, Dh = 32, 512, 128
    return {
        "x": _w((lambda *s: torch.randn(*s, dtype=torch.bfloat16) * 0.8)(B, Sq, D)),
        "k_cache": _w((lambda *s: torch.randn(*s, dtype=torch.bfloat16) * 0.8)(B, H, Sk, Dh)),
        "v_cache": _w((lambda *s: torch.randn(*s, dtype=torch.bfloat16) * 0.05)(B, H, Sk, Dh)),
        "wq": _w((lambda *s: torch.randn(*s, dtype=torch.bfloat16) * 0.8)(D, H * Dh) * (D ** -0.5)),
        "wo": _w((lambda *s: torch.randn(*s, dtype=torch.bfloat16) * 0.05)(H * Dh, D) * ((H * Dh) ** -0.5)),
    }

def reference(x, k_cache, v_cache, wq, wo):
    B, Sq, D = x.shape
    H, Dh = 32, 128
    q = (lambda x, *d: x.permute(*d))((x @ wq).reshape(B, Sq, H, Dh), 0, 2, 1, 3)
    scores = torch.einsum("bhqd,bhkd->bhqk", q, k_cache) * (Dh ** -0.5)
    p = _softmax(scores, axis=-1)
    o = torch.einsum("bhqk,bhkd->bhqd", p, v_cache)
    return (lambda x, *d: x.permute(*d))(o, 0, 2, 1, 3).reshape(B, Sq, H * Dh) @ wo
```

```asm
; @launch kernel=mha_attn_kernel grid=(1024,1,1) block=(256,1,1) lds=65536
; @launch kernel=mha_oproj_kernel grid=(256,1,1) block=(256,1,1) lds=65536
.amdgcn_target "amdgcn-amd-amdhsa--gfx950"
.text
.globl mha_attn_kernel
.p2align 8
.type mha_attn_kernel,@function
mha_attn_kernel:
    s_cmp_ge_u32 s2, 1024
    s_cbranch_scc1 K1_END
    s_load_dwordx8 s[8:15], s[0:1], 0
    s_load_dwordx2 s[16:17], s[0:1], 56
    s_lshr_b32 s4, s2, 5
    s_and_b32 s5, s2, 31
    v_lshrrev_b32 v1, 6, v0
    s_nop 0
    v_readfirstlane_b32 s6, v1
    v_and_b32 v0, 63, v0
    s_waitcnt lgkmcnt(0)
    s_mov_b32 s20, s8
    s_and_b32 s21, s9, 0xffff
    s_mov_b32 s22, 4718592
    s_mov_b32 s23, 0x00020000
    s_mov_b32 s24, s10
    s_and_b32 s25, s11, 0xffff
    s_mov_b32 s26, 134217728
    s_mov_b32 s27, 0x00020000
    s_mov_b32 s28, s12
    s_and_b32 s29, s13, 0xffff
    s_mov_b32 s30, 134217728
    s_mov_b32 s31, 0x00020000
    s_mov_b32 s32, s14
    s_and_b32 s33, s15, 0xffff
    s_mov_b32 s34, 4194304
    s_mov_b32 s35, 0x00020000
    s_mov_b32 s36, s16
    s_and_b32 s37, s17, 0xffff
    s_mov_b32 s38, 37748736
    s_mov_b32 s39, 0x00020000
    s_cmp_eq_u32 s6, 3
    s_cbranch_scc1 K1_LOADER
    v_and_b32 v1, 15, v0
    v_lshrrev_b32 v2, 4, v0
    v_xor_b32 v3, v1, v2
    v_lshlrev_b32 v3, 4, v3
    v_lshl_add_u32 v245, v1, 8, v3
    v_lshrrev_b32 v3, 2, v1
    v_and_b32 v4, 3, v1
    v_lshl_add_u32 v5, v2, 2, v3
    v_and_b32 v6, 7, v5
    v_lshlrev_b32 v6, 1, v6
    v_lshrrev_b32 v7, 1, v4
    v_xor_b32 v6, v6, v7
    v_lshlrev_b32 v6, 4, v6
    v_and_b32 v7, 1, v4
    v_lshl_add_u32 v6, v7, 3, v6
    v_lshl_add_u32 v246, v5, 8, v6
    v_lshl_add_u32 v5, v2, 3, v3
    v_lshlrev_b32 v6, 2, v3
    v_xor_b32 v6, v6, v4
    v_lshlrev_b32 v6, 4, v6
    v_lshl_add_u32 v247, v5, 8, v6
    s_mul_i32 s7, s4, 144
    s_mul_i32 s18, s6, 48
    s_add_u32 s7, s7, s18
    v_add_u32 v3, s7, v1
    v_lshlrev_b32 v3, 10, v3
    v_lshl_add_u32 v248, v2, 4, v3
    v_add_u32 v3, s7, v1
    v_lshlrev_b32 v3, 13, v3
    s_lshl_b32 s18, s5, 8
    v_add_u32 v3, s18, v3
    v_lshl_add_u32 v249, v2, 3, v3
    s_movk_i32 s40, 0x4000
    s_movk_i32 s41, 0x0
    s_mov_b32 s42, 0x8000
    v_mov_b32 v48, 0
    v_mov_b32 v49, 0
    v_mov_b32 v50, 0
    v_mov_b32 v51, 0
    v_mov_b32 v52, 0
    v_mov_b32 v53, 0
    v_mov_b32 v54, 0
    v_mov_b32 v55, 0
    v_mov_b32 v56, 0
    v_mov_b32 v57, 0
    v_mov_b32 v58, 0
    v_mov_b32 v59, 0
    v_mov_b32 v60, 0
    v_mov_b32 v61, 0
    v_mov_b32 v62, 0
    v_mov_b32 v63, 0
    v_mov_b32 v64, 0
    v_mov_b32 v65, 0
    v_mov_b32 v66, 0
    v_mov_b32 v67, 0
    v_mov_b32 v68, 0
    v_mov_b32 v69, 0
    v_mov_b32 v70, 0
    v_mov_b32 v71, 0
    v_mov_b32 v72, 0
    v_mov_b32 v73, 0
    v_mov_b32 v74, 0
    v_mov_b32 v75, 0
    v_mov_b32 v76, 0
    v_mov_b32 v77, 0
    v_mov_b32 v78, 0
    v_mov_b32 v79, 0
    v_mov_b32 v80, 0
    v_mov_b32 v81, 0
    v_mov_b32 v82, 0
    v_mov_b32 v83, 0
    v_mov_b32 v84, 0
    v_mov_b32 v85, 0
    v_mov_b32 v86, 0
    v_mov_b32 v87, 0
    v_mov_b32 v88, 0
    v_mov_b32 v89, 0
    v_mov_b32 v90, 0
    v_mov_b32 v91, 0
    v_mov_b32 v92, 0
    v_mov_b32 v93, 0
    v_mov_b32 v94, 0
    v_mov_b32 v95, 0
    v_mov_b32 v96, 0
    v_mov_b32 v97, 0
    v_mov_b32 v98, 0
    v_mov_b32 v99, 0
    v_mov_b32 v100, 0
    v_mov_b32 v101, 0
    v_mov_b32 v102, 0
    v_mov_b32 v103, 0
    v_mov_b32 v104, 0
    v_mov_b32 v105, 0
    v_mov_b32 v106, 0
    v_mov_b32 v107, 0
    v_mov_b32 v108, 0
    v_mov_b32 v109, 0
    v_mov_b32 v110, 0
    v_mov_b32 v111, 0
    v_mov_b32 v112, 0
    v_mov_b32 v113, 0
    v_mov_b32 v114, 0
    v_mov_b32 v115, 0
    v_mov_b32 v116, 0
    v_mov_b32 v117, 0
    v_mov_b32 v118, 0
    v_mov_b32 v119, 0
    v_mov_b32 v120, 0
    v_mov_b32 v121, 0
    v_mov_b32 v122, 0
    v_mov_b32 v123, 0
    v_mov_b32 v124, 0
    v_mov_b32 v125, 0
    v_mov_b32 v126, 0
    v_mov_b32 v127, 0
    v_mov_b32 v128, 0
    v_mov_b32 v129, 0
    v_mov_b32 v130, 0
    v_mov_b32 v131, 0
    v_mov_b32 v132, 0
    v_mov_b32 v133, 0
    v_mov_b32 v134, 0
    v_mov_b32 v135, 0
    v_mov_b32 v136, 0
    v_mov_b32 v137, 0
    v_mov_b32 v138, 0
    v_mov_b32 v139, 0
    v_mov_b32 v140, 0
    v_mov_b32 v141, 0
    v_mov_b32 v142, 0
    v_mov_b32 v143, 0
    buffer_load_dwordx4 v[144:147], v248, s[20:23], s41 offen offset:0
    buffer_load_dwordx4 v[148:151], v248, s[20:23], s41 offen offset:64
    buffer_load_dwordx4 v[152:155], v248, s[20:23], s40 offen offset:0
    buffer_load_dwordx4 v[156:159], v248, s[20:23], s40 offen offset:64
    buffer_load_dwordx4 v[160:163], v248, s[20:23], s42 offen offset:0
    buffer_load_dwordx4 v[164:167], v248, s[20:23], s42 offen offset:64
    s_barrier
    buffer_load_dwordx4 v[168:171], v248, s[20:23], s41 offen offset:128
    buffer_load_dwordx4 v[172:175], v248, s[20:23], s41 offen offset:192
    buffer_load_dwordx4 v[176:179], v248, s[20:23], s40 offen offset:128
    buffer_load_dwordx4 v[180:183], v248, s[20:23], s40 offen offset:192
    buffer_load_dwordx4 v[184:187], v248, s[20:23], s42 offen offset:128
    buffer_load_dwordx4 v[188:191], v248, s[20:23], s42 offen offset:192
    v_xor_b32 v241, 0, v247
    ds_read_b64_tr_b16 v[216:217], v241 offset:0
    ds_read_b64_tr_b16 v[218:219], v241 offset:1024
    v_xor_b32 v241, 0, v247
    ds_read_b64_tr_b16 v[220:221], v241 offset:8
    ds_read_b64_tr_b16 v[222:223], v241 offset:1032
    s_waitcnt vmcnt(6)
    v_xor_b32 v241, 64, v247
    ds_read_b64_tr_b16 v[224:225], v241 offset:0
    ds_read_b64_tr_b16 v[226:227], v241 offset:1024
    s_waitcnt lgkmcnt(4)
    v_mfma_f32_16x16x32_bf16 v[48:51], v[216:219], v[144:147], v[48:51]
    v_mfma_f32_16x16x32_bf16 v[52:55], v[216:219], v[152:155], v[52:55]
    v_mfma_f32_16x16x32_bf16 v[56:59], v[216:219], v[160:163], v[56:59]
    v_xor_b32 v241, 64, v247
    ds_read_b64_tr_b16 v[228:229], v241 offset:8
    ds_read_b64_tr_b16 v[230:231], v241 offset:1032
    s_waitcnt lgkmcnt(4)
    v_mfma_f32_16x16x32_bf16 v[60:63], v[220:223], v[144:147], v[60:63]
    v_mfma_f32_16x16x32_bf16 v[64:67], v[220:223], v[152:155], v[64:67]
    v_mfma_f32_16x16x32_bf16 v[68:71], v[220:223], v[160:163], v[68:71]
    v_xor_b32 v241, 128, v247
    ds_read_b64_tr_b16 v[216:217], v241 offset:0
    ds_read_b64_tr_b16 v[218:219], v241 offset:1024
    s_waitcnt lgkmcnt(4)
    v_mfma_f32_16x16x32_bf16 v[72:75], v[224:227], v[144:147], v[72:75]
    v_mfma_f32_16x16x32_bf16 v[76:79], v[224:227], v[152:155], v[76:79]
    v_mfma_f32_16x16x32_bf16 v[80:83], v[224:227], v[160:163], v[80:83]
    v_xor_b32 v241, 128, v247
    ds_read_b64_tr_b16 v[220:221], v241 offset:8
    ds_read_b64_tr_b16 v[222:223], v241 offset:1032
    s_waitcnt lgkmcnt(4)
    v_mfma_f32_16x16x32_bf16 v[84:87], v[228:231], v[144:147], v[84:87]
    v_mfma_f32_16x16x32_bf16 v[88:91], v[228:231], v[152:155], v[88:91]
    v_mfma_f32_16x16x32_bf16 v[92:95], v[228:231], v[160:163], v[92:95]
    v_xor_b32 v241, 192, v247
    ds_read_b64_tr_b16 v[224:225], v241 offset:0
    ds_read_b64_tr_b16 v[226:227], v241 offset:1024
    s_waitcnt lgkmcnt(4)
    v_mfma_f32_16x16x32_bf16 v[96:99], v[216:219], v[144:147], v[96:99]
    v_mfma_f32_16x16x32_bf16 v[100:103], v[216:219], v[152:155], v[100:103]
    v_mfma_f32_16x16x32_bf16 v[104:107], v[216:219], v[160:163], v[104:107]
    v_xor_b32 v241, 192, v247
    ds_read_b64_tr_b16 v[228:229], v241 offset:8
    ds_read_b64_tr_b16 v[230:231], v241 offset:1032
    s_waitcnt lgkmcnt(4)
    v_mfma_f32_16x16x32_bf16 v[108:111], v[220:223], v[144:147], v[108:111]
    v_mfma_f32_16x16x32_bf16 v[112:115], v[220:223], v[152:155], v[112:115]
    v_mfma_f32_16x16x32_bf16 v[116:119], v[220:223], v[160:163], v[116:119]
    v_xor_b32 v241, 0, v247
    ds_read_b64_tr_b16 v[216:217], v241 offset:8192
    ds_read_b64_tr_b16 v[218:219], v241 offset:9216
    s_waitcnt lgkmcnt(4)
    v_mfma_f32_16x16x32_bf16 v[120:123], v[224:227], v[144:147], v[120:123]
    v_mfma_f32_16x16x32_bf16 v[124:127], v[224:227], v[152:155], v[124:127]
    v_mfma_f32_16x16x32_bf16 v[128:131], v[224:227], v[160:163], v[128:131]
    v_xor_b32 v241, 0, v247
    ds_read_b64_tr_b16 v[220:221], v241 offset:8200
    ds_read_b64_tr_b16 v[222:223], v241 offset:9224
    s_waitcnt lgkmcnt(4)
    v_mfma_f32_16x16x32_bf16 v[132:135], v[228:231], v[144:147], v[132:135]
    v_mfma_f32_16x16x32_bf16 v[136:139], v[228:231], v[152:155], v[136:139]
    v_mfma_f32_16x16x32_bf16 v[140:143], v[228:231], v[160:163], v[140:143]
    v_xor_b32 v241, 64, v247
    ds_read_b64_tr_b16 v[224:225], v241 offset:8192
    ds_read_b64_tr_b16 v[226:227], v241 offset:9216
    s_waitcnt lgkmcnt(4)
    v_mfma_f32_16x16x32_bf16 v[48:51], v[216:219], v[148:151], v[48:51]
    v_mfma_f32_16x16x32_bf16 v[52:55], v[216:219], v[156:159], v[52:55]
    v_mfma_f32_16x16x32_bf16 v[56:59], v[216:219], v[164:167], v[56:59]
    v_xor_b32 v241, 64, v247
    ds_read_b64_tr_b16 v[228:229], v241 offset:8200
    ds_read_b64_tr_b16 v[230:231], v241 offset:9224
    s_waitcnt lgkmcnt(4)
    v_mfma_f32_16x16x32_bf16 v[60:63], v[220:223], v[148:151], v[60:63]
    v_mfma_f32_16x16x32_bf16 v[64:67], v[220:223], v[156:159], v[64:67]
    v_mfma_f32_16x16x32_bf16 v[68:71], v[220:223], v[164:167], v[68:71]
    v_xor_b32 v241, 128, v247
    ds_read_b64_tr_b16 v[216:217], v241 offset:8192
    ds_read_b64_tr_b16 v[218:219], v241 offset:9216
    s_waitcnt lgkmcnt(4)
    v_mfma_f32_16x16x32_bf16 v[72:75], v[224:227], v[148:151], v[72:75]
    v_mfma_f32_16x16x32_bf16 v[76:79], v[224:227], v[156:159], v[76:79]
    v_mfma_f32_16x16x32_bf16 v[80:83], v[224:227], v[164:167], v[80:83]
    v_xor_b32 v241, 128, v247
    ds_read_b64_tr_b16 v[220:221], v241 offset:8200
    ds_read_b64_tr_b16 v[222:223], v241 offset:9224
    s_waitcnt lgkmcnt(4)
    v_mfma_f32_16x16x32_bf16 v[84:87], v[228:231], v[148:151], v[84:87]
    v_mfma_f32_16x16x32_bf16 v[88:91], v[228:231], v[156:159], v[88:91]
    v_mfma_f32_16x16x32_bf16 v[92:95], v[228:231], v[164:167], v[92:95]
    v_xor_b32 v241, 192, v247
    ds_read_b64_tr_b16 v[224:225], v241 offset:8192
    ds_read_b64_tr_b16 v[226:227], v241 offset:9216
    s_waitcnt lgkmcnt(4)
    v_mfma_f32_16x16x32_bf16 v[96:99], v[216:219], v[148:151], v[96:99]
    v_mfma_f32_16x16x32_bf16 v[100:103], v[216:219], v[156:159], v[100:103]
    v_mfma_f32_16x16x32_bf16 v[104:107], v[216:219], v[164:167], v[104:107]
    v_xor_b32 v241, 192, v247
    ds_read_b64_tr_b16 v[228:229], v241 offset:8200
    ds_read_b64_tr_b16 v[230:231], v241 offset:9224
    s_waitcnt lgkmcnt(4)
    v_mfma_f32_16x16x32_bf16 v[108:111], v[220:223], v[148:151], v[108:111]
    v_mfma_f32_16x16x32_bf16 v[112:115], v[220:223], v[156:159], v[112:115]
    v_mfma_f32_16x16x32_bf16 v[116:119], v[220:223], v[164:167], v[116:119]
    s_waitcnt lgkmcnt(2)
    v_mfma_f32_16x16x32_bf16 v[120:123], v[224:227], v[148:151], v[120:123]
    v_mfma_f32_16x16x32_bf16 v[124:127], v[224:227], v[156:159], v[124:127]
    v_mfma_f32_16x16x32_bf16 v[128:131], v[224:227], v[164:167], v[128:131]
    s_waitcnt lgkmcnt(0)
    v_mfma_f32_16x16x32_bf16 v[132:135], v[228:231], v[148:151], v[132:135]
    v_mfma_f32_16x16x32_bf16 v[136:139], v[228:231], v[156:159], v[136:139]
    v_mfma_f32_16x16x32_bf16 v[140:143], v[228:231], v[164:167], v[140:143]
    s_barrier
    buffer_load_dwordx4 v[144:147], v248, s[20:23], s41 offen offset:256
    buffer_load_dwordx4 v[148:151], v248, s[20:23], s41 offen offset:320
    buffer_load_dwordx4 v[152:155], v248, s[20:23], s40 offen offset:256
    buffer_load_dwordx4 v[156:159], v248, s[20:23], s40 offen offset:320
    buffer_load_dwordx4 v[160:163], v248, s[20:23], s42 offen offset:256
    buffer_load_dwordx4 v[164:167], v248, s[20:23], s42 offen offset:320
    v_xor_b32 v241, 0, v247
    ds_read_b64_tr_b16 v[216:217], v241 offset:16384
    ds_read_b64_tr_b16 v[218:219], v241 offset:17408
    v_xor_b32 v241, 0, v247
    ds_read_b64_tr_b16 v[220:221], v241 offset:16392
    ds_read_b64_tr_b16 v[222:223], v241 offset:17416
    s_waitcnt vmcnt(6)
    v_xor_b32 v241, 64, v247
    ds_read_b64_tr_b16 v[224:225], v241 offset:16384
    ds_read_b64_tr_b16 v[226:227], v241 offset:17408
    s_waitcnt lgkmcnt(4)
    v_mfma_f32_16x16x32_bf16 v[48:51], v[216:219], v[168:171], v[48:51]
    v_mfma_f32_16x16x32_bf16 v[52:55], v[216:219], v[176:179], v[52:55]
    v_mfma_f32_16x16x32_bf16 v[56:59], v[216:219], v[184:187], v[56:59]
    v_xor_b32 v241, 64, v247
    ds_read_b64_tr_b16 v[228:229], v241 offset:16392
    ds_read_b64_tr_b16 v[230:231], v241 offset:17416
    s_waitcnt lgkmcnt(4)
    v_mfma_f32_16x16x32_bf16 v[60:63], v[220:223], v[168:171], v[60:63]
    v_mfma_f32_16x16x32_bf16 v[64:67], v[220:223], v[176:179], v[64:67]
    v_mfma_f32_16x16x32_bf16 v[68:71], v[220:223], v[184:187], v[68:71]
    v_xor_b32 v241, 128, v247
    ds_read_b64_tr_b16 v[216:217], v241 offset:16384
    ds_read_b64_tr_b16 v[218:219], v241 offset:17408
    s_waitcnt lgkmcnt(4)
    v_mfma_f32_16x16x32_bf16 v[72:75], v[224:227], v[168:171], v[72:75]
    v_mfma_f32_16x16x32_bf16 v[76:79], v[224:227], v[176:179], v[76:79]
    v_mfma_f32_16x16x32_bf16 v[80:83], v[224:227], v[184:187], v[80:83]
    v_xor_b32 v241, 128, v247
    ds_read_b64_tr_b16 v[220:221], v241 offset:16392
    ds_read_b64_tr_b16 v[222:223], v241 offset:17416
    s_waitcnt lgkmcnt(4)
    v_mfma_f32_16x16x32_bf16 v[84:87], v[228:231], v[168:171], v[84:87]
    v_mfma_f32_16x16x32_bf16 v[88:91], v[228:231], v[176:179], v[88:91]
    v_mfma_f32_16x16x32_bf16 v[92:95], v[228:231], v[184:187], v[92:95]
    v_xor_b32 v241, 192, v247
    ds_read_b64_tr_b16 v[224:225], v241 offset:16384
    ds_read_b64_tr_b16 v[226:227], v241 offset:17408
    s_waitcnt lgkmcnt(4)
    v_mfma_f32_16x16x32_bf16 v[96:99], v[216:219], v[168:171], v[96:99]
    v_mfma_f32_16x16x32_bf16 v[100:103], v[216:219], v[176:179], v[100:103]
    v_mfma_f32_16x16x32_bf16 v[104:107], v[216:219], v[184:187], v[104:107]
    v_xor_b32 v241, 192, v247
    ds_read_b64_tr_b16 v[228:229], v241 offset:16392
    ds_read_b64_tr_b16 v[230:231], v241 offset:17416
    s_waitcnt lgkmcnt(4)
    v_mfma_f32_16x16x32_bf16 v[108:111], v[220:223], v[168:171], v[108:111]
    v_mfma_f32_16x16x32_bf16 v[112:115], v[220:223], v[176:179], v[112:115]
    v_mfma_f32_16x16x32_bf16 v[116:119], v[220:223], v[184:187], v[116:119]
    v_xor_b32 v241, 0, v247
    ds_read_b64_tr_b16 v[216:217], v241 offset:24576
    ds_read_b64_tr_b16 v[218:219], v241 offset:25600
    s_waitcnt lgkmcnt(4)
    v_mfma_f32_16x16x32_bf16 v[120:123], v[224:227], v[168:171], v[120:123]
    v_mfma_f32_16x16x32_bf16 v[124:127], v[224:227], v[176:179], v[124:127]
    v_mfma_f32_16x16x32_bf16 v[128:131], v[224:227], v[184:187], v[128:131]
    v_xor_b32 v241, 0, v247
    ds_read_b64_tr_b16 v[220:221], v241 offset:24584
    ds_read_b64_tr_b16 v[222:223], v241 offset:25608
    s_waitcnt lgkmcnt(4)
    v_mfma_f32_16x16x32_bf16 v[132:135], v[228:231], v[168:171], v[132:135]
    v_mfma_f32_16x16x32_bf16 v[136:139], v[228:231], v[176:179], v[136:139]
    v_mfma_f32_16x16x32_bf16 v[140:143], v[228:231], v[184:187], v[140:143]
    v_xor_b32 v241, 64, v247
    ds_read_b64_tr_b16 v[224:225], v241 offset:24576
    ds_read_b64_tr_b16 v[226:227], v241 offset:25600
    s_waitcnt lgkmcnt(4)
    v_mfma_f32_16x16x32_bf16 v[48:51], v[216:219], v[172:175], v[48:51]
    v_mfma_f32_16x16x32_bf16 v[52:55], v[216:219], v[180:183], v[52:55]
    v_mfma_f32_16x16x32_bf16 v[56:59], v[216:219], v[188:191], v[56:59]
    v_xor_b32 v241, 64, v247
    ds_read_b64_tr_b16 v[228:229], v241 offset:24584
    ds_read_b64_tr_b16 v[230:231], v241 offset:25608
    s_waitcnt lgkmcnt(4)
    v_mfma_f32_16x16x32_bf16 v[60:63], v[220:223], v[172:175], v[60:63]
    v_mfma_f32_16x16x32_bf16 v[64:67], v[220:223], v[180:183], v[64:67]
    v_mfma_f32_16x16x32_bf16 v[68:71], v[220:223], v[188:191], v[68:71]
    v_xor_b32 v241, 128, v247
    ds_read_b64_tr_b16 v[216:217], v241 offset:24576
    ds_read_b64_tr_b16 v[218:219], v241 offset:25600
    s_waitcnt lgkmcnt(4)
    v_mfma_f32_16x16x32_bf16 v[72:75], v[224:227], v[172:175], v[72:75]
    v_mfma_f32_16x16x32_bf16 v[76:79], v[224:227], v[180:183], v[76:79]
    v_mfma_f32_16x16x32_bf16 v[80:83], v[224:227], v[188:191], v[80:83]
    v_xor_b32 v241, 128, v247
    ds_read_b64_tr_b16 v[220:221], v241 offset:24584
    ds_read_b64_tr_b16 v[222:223], v241 offset:25608
    s_waitcnt lgkmcnt(4)
    v_mfma_f32_16x16x32_bf16 v[84:87], v[228:231], v[172:175], v[84:87]
    v_mfma_f32_16x16x32_bf16 v[88:91], v[228:231], v[180:183], v[88:91]
    v_mfma_f32_16x16x32_bf16 v[92:95], v[228:231], v[188:191], v[92:95]
    v_xor_b32 v241, 192, v247
    ds_read_b64_tr_b16 v[224:225], v241 offset:24576
    ds_read_b64_tr_b16 v[226:227], v241 offset:25600
    s_waitcnt lgkmcnt(4)
    v_mfma_f32_16x16x32_bf16 v[96:99], v[216:219], v[172:175], v[96:99]
    v_mfma_f32_16x16x32_bf16 v[100:103], v[216:219], v[180:183], v[100:103]
    v_mfma_f32_16x16x32_bf16 v[104:107], v[216:219], v[188:191], v[104:107]
    v_xor_b32 v241, 192, v247
    ds_read_b64_tr_b16 v[228:229], v241 offset:24584
    ds_read_b64_tr_b16 v[230:231], v241 offset:25608
    s_waitcnt lgkmcnt(4)
    v_mfma_f32_16x16x32_bf16 v[108:111], v[220:223], v[172:175], v[108:111]
    v_mfma_f32_16x16x32_bf16 v[112:115], v[220:223], v[180:183], v[112:115]
    v_mfma_f32_16x16x32_bf16 v[116:119], v[220:223], v[188:191], v[116:119]
    s_waitcnt lgkmcnt(2)
    v_mfma_f32_16x16x32_bf16 v[120:123], v[224:227], v[172:175], v[120:123]
    v_mfma_f32_16x16x32_bf16 v[124:127], v[224:227], v[180:183], v[124:127]
    v_mfma_f32_16x16x32_bf16 v[128:131], v[224:227], v[188:191], v[128:131]
    s_waitcnt lgkmcnt(0)
    v_mfma_f32_16x16x32_bf16 v[132:135], v[228:231], v[172:175], v[132:135]
    v_mfma_f32_16x16x32_bf16 v[136:139], v[228:231], v[180:183], v[136:139]
    v_mfma_f32_16x16x32_bf16 v[140:143], v[228:231], v[188:191], v[140:143]
    s_barrier
    buffer_load_dwordx4 v[168:171], v248, s[20:23], s41 offen offset:384
    buffer_load_dwordx4 v[172:175], v248, s[20:23], s41 offen offset:448
    buffer_load_dwordx4 v[176:179], v248, s[20:23], s40 offen offset:384
    buffer_load_dwordx4 v[180:183], v248, s[20:23], s40 offen offset:448
    buffer_load_dwordx4 v[184:187], v248, s[20:23], s42 offen offset:384
    buffer_load_dwordx4 v[188:191], v248, s[20:23], s42 offen offset:448
    v_xor_b32 v241, 0, v247
    ds_read_b64_tr_b16 v[216:217], v241 offset:32768
    ds_read_b64_tr_b16 v[218:219], v241 offset:33792
    v_xor_b32 v241, 0, v247
    ds_read_b64_tr_b16 v[220:221], v241 offset:32776
    ds_read_b64_tr_b16 v[222:223], v241 offset:33800
    s_waitcnt vmcnt(6)
    v_xor_b32 v241, 64, v247
    ds_read_b64_tr_b16 v[224:225], v241 offset:32768
    ds_read_b64_tr_b16 v[226:227], v241 offset:33792
    s_waitcnt lgkmcnt(4)
    v_mfma_f32_16x16x32_bf16 v[48:51], v[216:219], v[144:147], v[48:51]
    v_mfma_f32_16x16x32_bf16 v[52:55], v[216:219], v[152:155], v[52:55]
    v_mfma_f32_16x16x32_bf16 v[56:59], v[216:219], v[160:163], v[56:59]
    v_xor_b32 v241, 64, v247
    ds_read_b64_tr_b16 v[228:229], v241 offset:32776
    ds_read_b64_tr_b16 v[230:231], v241 offset:33800
    s_waitcnt lgkmcnt(4)
    v_mfma_f32_16x16x32_bf16 v[60:63], v[220:223], v[144:147], v[60:63]
    v_mfma_f32_16x16x32_bf16 v[64:67], v[220:223], v[152:155], v[64:67]
    v_mfma_f32_16x16x32_bf16 v[68:71], v[220:223], v[160:163], v[68:71]
    v_xor_b32 v241, 128, v247
    ds_read_b64_tr_b16 v[216:217], v241 offset:32768
    ds_read_b64_tr_b16 v[218:219], v241 offset:33792
    s_waitcnt lgkmcnt(4)
    v_mfma_f32_16x16x32_bf16 v[72:75], v[224:227], v[144:147], v[72:75]
    v_mfma_f32_16x16x32_bf16 v[76:79], v[224:227], v[152:155], v[76:79]
    v_mfma_f32_16x16x32_bf16 v[80:83], v[224:227], v[160:163], v[80:83]
    v_xor_b32 v241, 128, v247
    ds_read_b64_tr_b16 v[220:221], v241 offset:32776
    ds_read_b64_tr_b16 v[222:223], v241 offset:33800
    s_waitcnt lgkmcnt(4)
    v_mfma_f32_16x16x32_bf16 v[84:87], v[228:231], v[144:147], v[84:87]
    v_mfma_f32_16x16x32_bf16 v[88:91], v[228:231], v[152:155], v[88:91]
    v_mfma_f32_16x16x32_bf16 v[92:95], v[228:231], v[160:163], v[92:95]
    v_xor_b32 v241, 192, v247
    ds_read_b64_tr_b16 v[224:225], v241 offset:32768
    ds_read_b64_tr_b16 v[226:227], v241 offset:33792
    s_waitcnt lgkmcnt(4)
    v_mfma_f32_16x16x32_bf16 v[96:99], v[216:219], v[144:147], v[96:99]
    v_mfma_f32_16x16x32_bf16 v[100:103], v[216:219], v[152:155], v[100:103]
    v_mfma_f32_16x16x32_bf16 v[104:107], v[216:219], v[160:163], v[104:107]
    v_xor_b32 v241, 192, v247
    ds_read_b64_tr_b16 v[228:229], v241 offset:32776
    ds_read_b64_tr_b16 v[230:231], v241 offset:33800
    s_waitcnt lgkmcnt(4)
    v_mfma_f32_16x16x32_bf16 v[108:111], v[220:223], v[144:147], v[108:111]
    v_mfma_f32_16x16x32_bf16 v[112:115], v[220:223], v[152:155], v[112:115]
    v_mfma_f32_16x16x32_bf16 v[116:119], v[220:223], v[160:163], v[116:119]
    v_xor_b32 v241, 0, v247
    ds_read_b64_tr_b16 v[216:217], v241 offset:40960
    ds_read_b64_tr_b16 v[218:219], v241 offset:41984
    s_waitcnt lgkmcnt(4)
    v_mfma_f32_16x16x32_bf16 v[120:123], v[224:227], v[144:147], v[120:123]
    v_mfma_f32_16x16x32_bf16 v[124:127], v[224:227], v[152:155], v[124:127]
    v_mfma_f32_16x16x32_bf16 v[128:131], v[224:227], v[160:163], v[128:131]
    v_xor_b32 v241, 0, v247
    ds_read_b64_tr_b16 v[220:221], v241 offset:40968
    ds_read_b64_tr_b16 v[222:223], v241 offset:41992
    s_waitcnt lgkmcnt(4)
    v_mfma_f32_16x16x32_bf16 v[132:135], v[228:231], v[144:147], v[132:135]
    v_mfma_f32_16x16x32_bf16 v[136:139], v[228:231], v[152:155], v[136:139]
    v_mfma_f32_16x16x32_bf16 v[140:143], v[228:231], v[160:163], v[140:143]
    v_xor_b32 v241, 64, v247
    ds_read_b64_tr_b16 v[224:225], v241 offset:40960
    ds_read_b64_tr_b16 v[226:227], v241 offset:41984
    s_waitcnt lgkmcnt(4)
    v_mfma_f32_16x16x32_bf16 v[48:51], v[216:219], v[148:151], v[48:51]
    v_mfma_f32_16x16x32_bf16 v[52:55], v[216:219], v[156:159], v[52:55]
    v_mfma_f32_16x16x32_bf16 v[56:59], v[216:219], v[164:167], v[56:59]
    v_xor_b32 v241, 64, v247
    ds_read_b64_tr_b16 v[228:229], v241 offset:40968
    ds_read_b64_tr_b16 v[230:231], v241 offset:41992
    s_waitcnt lgkmcnt(4)
    v_mfma_f32_16x16x32_bf16 v[60:63], v[220:223], v[148:151], v[60:63]
    v_mfma_f32_16x16x32_bf16 v[64:67], v[220:223], v[156:159], v[64:67]
    v_mfma_f32_16x16x32_bf16 v[68:71], v[220:223], v[164:167], v[68:71]
    v_xor_b32 v241, 128, v247
    ds_read_b64_tr_b16 v[216:217], v241 offset:40960
    ds_read_b64_tr_b16 v[218:219], v241 offset:41984
    s_waitcnt lgkmcnt(4)
    v_mfma_f32_16x16x32_bf16 v[72:75], v[224:227], v[148:151], v[72:75]
    v_mfma_f32_16x16x32_bf16 v[76:79], v[224:227], v[156:159], v[76:79]
    v_mfma_f32_16x16x32_bf16 v[80:83], v[224:227], v[164:167], v[80:83]
    v_xor_b32 v241, 128, v247
    ds_read_b64_tr_b16 v[220:221], v241 offset:40968
    ds_read_b64_tr_b16 v[222:223], v241 offset:41992
    s_waitcnt lgkmcnt(4)
    v_mfma_f32_16x16x32_bf16 v[84:87], v[228:231], v[148:151], v[84:87]
    v_mfma_f32_16x16x32_bf16 v[88:91], v[228:231], v[156:159], v[88:91]
    v_mfma_f32_16x16x32_bf16 v[92:95], v[228:231], v[164:167], v[92:95]
    v_xor_b32 v241, 192, v247
    ds_read_b64_tr_b16 v[224:225], v241 offset:40960
    ds_read_b64_tr_b16 v[226:227], v241 offset:41984
    s_waitcnt lgkmcnt(4)
    v_mfma_f32_16x16x32_bf16 v[96:99], v[216:219], v[148:151], v[96:99]
    v_mfma_f32_16x16x32_bf16 v[100:103], v[216:219], v[156:159], v[100:103]
    v_mfma_f32_16x16x32_bf16 v[104:107], v[216:219], v[164:167], v[104:107]
    v_xor_b32 v241, 192, v247
    ds_read_b64_tr_b16 v[228:229], v241 offset:40968
    ds_read_b64_tr_b16 v[230:231], v241 offset:41992
    s_waitcnt lgkmcnt(4)
    v_mfma_f32_16x16x32_bf16 v[108:111], v[220:223], v[148:151], v[108:111]
    v_mfma_f32_16x16x32_bf16 v[112:115], v[220:223], v[156:159], v[112:115]
    v_mfma_f32_16x16x32_bf16 v[116:119], v[220:223], v[164:167], v[116:119]
    s_waitcnt lgkmcnt(2)
    v_mfma_f32_16x16x32_bf16 v[120:123], v[224:227], v[148:151], v[120:123]
    v_mfma_f32_16x16x32_bf16 v[124:127], v[224:227], v[156:159], v[124:127]
    v_mfma_f32_16x16x32_bf16 v[128:131], v[224:227], v[164:167], v[128:131]
    s_waitcnt lgkmcnt(0)
    v_mfma_f32_16x16x32_bf16 v[132:135], v[228:231], v[148:151], v[132:135]
    v_mfma_f32_16x16x32_bf16 v[136:139], v[228:231], v[156:159], v[136:139]
    v_mfma_f32_16x16x32_bf16 v[140:143], v[228:231], v[164:167], v[140:143]
    s_barrier
    buffer_load_dwordx4 v[144:147], v248, s[20:23], s41 offen offset:512
    buffer_load_dwordx4 v[148:151], v248, s[20:23], s41 offen offset:576
    buffer_load_dwordx4 v[152:155], v248, s[20:23], s40 offen offset:512
    buffer_load_dwordx4 v[156:159], v248, s[20:23], s40 offen offset:576
    buffer_load_dwordx4 v[160:163], v248, s[20:23], s42 offen offset:512
    buffer_load_dwordx4 v[164:167], v248, s[20:23], s42 offen offset:576
    v_xor_b32 v241, 0, v247
    ds_read_b64_tr_b16 v[216:217], v241 offset:49152
    ds_read_b64_tr_b16 v[218:219], v241 offset:50176
    v_xor_b32 v241, 0, v247
    ds_read_b64_tr_b16 v[220:221], v241 offset:49160
    ds_read_b64_tr_b16 v[222:223], v241 offset:50184
    s_waitcnt vmcnt(6)
    v_xor_b32 v241, 64, v247
    ds_read_b64_tr_b16 v[224:225], v241 offset:49152
    ds_read_b64_tr_b16 v[226:227], v241 offset:50176
    s_waitcnt lgkmcnt(4)
    v_mfma_f32_16x16x32_bf16 v[48:51], v[216:219], v[168:171], v[48:51]
    v_mfma_f32_16x16x32_bf16 v[52:55], v[216:219], v[176:179], v[52:55]
    v_mfma_f32_16x16x32_bf16 v[56:59], v[216:219], v[184:187], v[56:59]
    v_xor_b32 v241, 64, v247
    ds_read_b64_tr_b16 v[228:229], v241 offset:49160
    ds_read_b64_tr_b16 v[230:231], v241 offset:50184
    s_waitcnt lgkmcnt(4)
    v_mfma_f32_16x16x32_bf16 v[60:63], v[220:223], v[168:171], v[60:63]
    v_mfma_f32_16x16x32_bf16 v[64:67], v[220:223], v[176:179], v[64:67]
    v_mfma_f32_16x16x32_bf16 v[68:71], v[220:223], v[184:187], v[68:71]
    v_xor_b32 v241, 128, v247
    ds_read_b64_tr_b16 v[216:217], v241 offset:49152
    ds_read_b64_tr_b16 v[218:219], v241 offset:50176
    s_waitcnt lgkmcnt(4)
    v_mfma_f32_16x16x32_bf16 v[72:75], v[224:227], v[168:171], v[72:75]
    v_mfma_f32_16x16x32_bf16 v[76:79], v[224:227], v[176:179], v[76:79]
    v_mfma_f32_16x16x32_bf16 v[80:83], v[224:227], v[184:187], v[80:83]
    v_xor_b32 v241, 128, v247
    ds_read_b64_tr_b16 v[220:221], v241 offset:49160
    ds_read_b64_tr_b16 v[222:223], v241 offset:50184
    s_waitcnt lgkmcnt(4)
    v_mfma_f32_16x16x32_bf16 v[84:87], v[228:231], v[168:171], v[84:87]
    v_mfma_f32_16x16x32_bf16 v[88:91], v[228:231], v[176:179], v[88:91]
    v_mfma_f32_16x16x32_bf16 v[92:95], v[228:231], v[184:187], v[92:95]
    v_xor_b32 v241, 192, v247
    ds_read_b64_tr_b16 v[224:225], v241 offset:49152
    ds_read_b64_tr_b16 v[226:227], v241 offset:50176
    s_waitcnt lgkmcnt(4)
    v_mfma_f32_16x16x32_bf16 v[96:99], v[216:219], v[168:171], v[96:99]
    v_mfma_f32_16x16x32_bf16 v[100:103], v[216:219], v[176:179], v[100:103]
    v_mfma_f32_16x16x32_bf16 v[104:107], v[216:219], v[184:187], v[104:107]
    v_xor_b32 v241, 192, v247
    ds_read_b64_tr_b16 v[228:229], v241 offset:49160
    ds_read_b64_tr_b16 v[230:231], v241 offset:50184
    s_waitcnt lgkmcnt(4)
    v_mfma_f32_16x16x32_bf16 v[108:111], v[220:223], v[168:171], v[108:111]
    v_mfma_f32_16x16x32_bf16 v[112:115], v[220:223], v[176:179], v[112:115]
    v_mfma_f32_16x16x32_bf16 v[116:119], v[220:223], v[184:187], v[116:119]
    v_xor_b32 v241, 0, v247
    ds_read_b64_tr_b16 v[216:217], v241 offset:57344
    ds_read_b64_tr_b16 v[218:219], v241 offset:58368
    s_waitcnt lgkmcnt(4)
    v_mfma_f32_16x16x32_bf16 v[120:123], v[224:227], v[168:171], v[120:123]
    v_mfma_f32_16x16x32_bf16 v[124:127], v[224:227], v[176:179], v[124:127]
    v_mfma_f32_16x16x32_bf16 v[128:131], v[224:227], v[184:187], v[128:131]
    v_xor_b32 v241, 0, v247
    ds_read_b64_tr_b16 v[220:221], v241 offset:57352
    ds_read_b64_tr_b16 v[222:223], v241 offset:58376
    s_waitcnt lgkmcnt(4)
    v_mfma_f32_16x16x32_bf16 v[132:135], v[228:231], v[168:171], v[132:135]
    v_mfma_f32_16x16x32_bf16 v[136:139], v[228:231], v[176:179], v[136:139]
    v_mfma_f32_16x16x32_bf16 v[140:143], v[228:231], v[184:187], v[140:143]
    v_xor_b32 v241, 64, v247
    ds_read_b64_tr_b16 v[224:225], v241 offset:57344
    ds_read_b64_tr_b16 v[226:227], v241 offset:58368
    s_waitcnt lgkmcnt(4)
    v_mfma_f32_16x16x32_bf16 v[48:51], v[216:219], v[172:175], v[48:51]
    v_mfma_f32_16x16x32_bf16 v[52:55], v[216:219], v[180:183], v[52:55]
    v_mfma_f32_16x16x32_bf16 v[56:59], v[216:219], v[188:191], v[56:59]
    v_xor_b32 v241, 64, v247
    ds_read_b64_tr_b16 v[228:229], v241 offset:57352
    ds_read_b64_tr_b16 v[230:231], v241 offset:58376
    s_waitcnt lgkmcnt(4)
    v_mfma_f32_16x16x32_bf16 v[60:63], v[220:223], v[172:175], v[60:63]
    v_mfma_f32_16x16x32_bf16 v[64:67], v[220:223], v[180:183], v[64:67]
    v_mfma_f32_16x16x32_bf16 v[68:71], v[220:223], v[188:191], v[68:71]
    v_xor_b32 v241, 128, v247
    ds_read_b64_tr_b16 v[216:217], v241 offset:57344
    ds_read_b64_tr_b16 v[218:219], v241 offset:58368
    s_waitcnt lgkmcnt(4)
    v_mfma_f32_16x16x32_bf16 v[72:75], v[224:227], v[172:175], v[72:75]
    v_mfma_f32_16x16x32_bf16 v[76:79], v[224:227], v[180:183], v[76:79]
    v_mfma_f32_16x16x32_bf16 v[80:83], v[224:227], v[188:191], v[80:83]
    v_xor_b32 v241, 128, v247
    ds_read_b64_tr_b16 v[220:221], v241 offset:57352
    ds_read_b64_tr_b16 v[222:223], v241 offset:58376
    s_waitcnt lgkmcnt(4)
    v_mfma_f32_16x16x32_bf16 v[84:87], v[228:231], v[172:175], v[84:87]
    v_mfma_f32_16x16x32_bf16 v[88:91], v[228:231], v[180:183], v[88:91]
    v_mfma_f32_16x16x32_bf16 v[92:95], v[228:231], v[188:191], v[92:95]
    v_xor_b32 v241, 192, v247
    ds_read_b64_tr_b16 v[224:225], v241 offset:57344
    ds_read_b64_tr_b16 v[226:227], v241 offset:58368
    s_waitcnt lgkmcnt(4)
    v_mfma_f32_16x16x32_bf16 v[96:99], v[216:219], v[172:175], v[96:99]
    v_mfma_f32_16x16x32_bf16 v[100:103], v[216:219], v[180:183], v[100:103]
    v_mfma_f32_16x16x32_bf16 v[104:107], v[216:219], v[188:191], v[104:107]
    v_xor_b32 v241, 192, v247
    ds_read_b64_tr_b16 v[228:229], v241 offset:57352
    ds_read_b64_tr_b16 v[230:231], v241 offset:58376
    s_waitcnt lgkmcnt(4)
    v_mfma_f32_16x16x32_bf16 v[108:111], v[220:223], v[172:175], v[108:111]
    v_mfma_f32_16x16x32_bf16 v[112:115], v[220:223], v[180:183], v[112:115]
    v_mfma_f32_16x16x32_bf16 v[116:119], v[220:223], v[188:191], v[116:119]
    s_waitcnt lgkmcnt(2)
    v_mfma_f32_16x16x32_bf16 v[120:123], v[224:227], v[172:175], v[120:123]
    v_mfma_f32_16x16x32_bf16 v[124:127], v[224:227], v[180:183], v[124:127]
    v_mfma_f32_16x16x32_bf16 v[128:131], v[224:227], v[188:191], v[128:131]
    s_waitcnt lgkmcnt(0)
    v_mfma_f32_16x16x32_bf16 v[132:135], v[228:231], v[172:175], v[132:135]
    v_mfma_f32_16x16x32_bf16 v[136:139], v[228:231], v[180:183], v[136:139]
    v_mfma_f32_16x16x32_bf16 v[140:143], v[228:231], v[188:191], v[140:143]
    s_barrier
    buffer_load_dwordx4 v[168:171], v248, s[20:23], s41 offen offset:640
    buffer_load_dwordx4 v[172:175], v248, s[20:23], s41 offen offset:704
    buffer_load_dwordx4 v[176:179], v248, s[20:23], s40 offen offset:640
    buffer_load_dwordx4 v[180:183], v248, s[20:23], s40 offen offset:704
    buffer_load_dwordx4 v[184:187], v248, s[20:23], s42 offen offset:640
    buffer_load_dwordx4 v[188:191], v248, s[20:23], s42 offen offset:704
    v_xor_b32 v241, 0, v247
    ds_read_b64_tr_b16 v[216:217], v241 offset:0
    ds_read_b64_tr_b16 v[218:219], v241 offset:1024
    v_xor_b32 v241, 0, v247
    ds_read_b64_tr_b16 v[220:221], v241 offset:8
    ds_read_b64_tr_b16 v[222:223], v241 offset:1032
    s_waitcnt vmcnt(6)
    v_xor_b32 v241, 64, v247
    ds_read_b64_tr_b16 v[224:225], v241 offset:0
    ds_read_b64_tr_b16 v[226:227], v241 offset:1024
    s_waitcnt lgkmcnt(4)
    v_mfma_f32_16x16x32_bf16 v[48:51], v[216:219], v[144:147], v[48:51]
    v_mfma_f32_16x16x32_bf16 v[52:55], v[216:219], v[152:155], v[52:55]
    v_mfma_f32_16x16x32_bf16 v[56:59], v[216:219], v[160:163], v[56:59]
    v_xor_b32 v241, 64, v247
    ds_read_b64_tr_b16 v[228:229], v241 offset:8
    ds_read_b64_tr_b16 v[230:231], v241 offset:1032
    s_waitcnt lgkmcnt(4)
    v_mfma_f32_16x16x32_bf16 v[60:63], v[220:223], v[144:147], v[60:63]
    v_mfma_f32_16x16x32_bf16 v[64:67], v[220:223], v[152:155], v[64:67]
    v_mfma_f32_16x16x32_bf16 v[68:71], v[220:223], v[160:163], v[68:71]
    v_xor_b32 v241, 128, v247
    ds_read_b64_tr_b16 v[216:217], v241 offset:0
    ds_read_b64_tr_b16 v[218:219], v241 offset:1024
    s_waitcnt lgkmcnt(4)
    v_mfma_f32_16x16x32_bf16 v[72:75], v[224:227], v[144:147], v[72:75]
    v_mfma_f32_16x16x32_bf16 v[76:79], v[224:227], v[152:155], v[76:79]
    v_mfma_f32_16x16x32_bf16 v[80:83], v[224:227], v[160:163], v[80:83]
    v_xor_b32 v241, 128, v247
    ds_read_b64_tr_b16 v[220:221], v241 offset:8
    ds_read_b64_tr_b16 v[222:223], v241 offset:1032
    s_waitcnt lgkmcnt(4)
    v_mfma_f32_16x16x32_bf16 v[84:87], v[228:231], v[144:147], v[84:87]
    v_mfma_f32_16x16x32_bf16 v[88:91], v[228:231], v[152:155], v[88:91]
    v_mfma_f32_16x16x32_bf16 v[92:95], v[228:231], v[160:163], v[92:95]
    v_xor_b32 v241, 192, v247
    ds_read_b64_tr_b16 v[224:225], v241 offset:0
    ds_read_b64_tr_b16 v[226:227], v241 offset:1024
    s_waitcnt lgkmcnt(4)
    v_mfma_f32_16x16x32_bf16 v[96:99], v[216:219], v[144:147], v[96:99]
    v_mfma_f32_16x16x32_bf16 v[100:103], v[216:219], v[152:155], v[100:103]
    v_mfma_f32_16x16x32_bf16 v[104:107], v[216:219], v[160:163], v[104:107]
    v_xor_b32 v241, 192, v247
    ds_read_b64_tr_b16 v[228:229], v241 offset:8
    ds_read_b64_tr_b16 v[230:231], v241 offset:1032
    s_waitcnt lgkmcnt(4)
    v_mfma_f32_16x16x32_bf16 v[108:111], v[220:223], v[144:147], v[108:111]
    v_mfma_f32_16x16x32_bf16 v[112:115], v[220:223], v[152:155], v[112:115]
    v_mfma_f32_16x16x32_bf16 v[116:119], v[220:223], v[160:163], v[116:119]
    v_xor_b32 v241, 0, v247
    ds_read_b64_tr_b16 v[216:217], v241 offset:8192
    ds_read_b64_tr_b16 v[218:219], v241 offset:9216
    s_waitcnt lgkmcnt(4)
    v_mfma_f32_16x16x32_bf16 v[120:123], v[224:227], v[144:147], v[120:123]
    v_mfma_f32_16x16x32_bf16 v[124:127], v[224:227], v[152:155], v[124:127]
    v_mfma_f32_16x16x32_bf16 v[128:131], v[224:227], v[160:163], v[128:131]
    v_xor_b32 v241, 0, v247
    ds_read_b64_tr_b16 v[220:221], v241 offset:8200
    ds_read_b64_tr_b16 v[222:223], v241 offset:9224
    s_waitcnt lgkmcnt(4)
    v_mfma_f32_16x16x32_bf16 v[132:135], v[228:231], v[144:147], v[132:135]
    v_mfma_f32_16x16x32_bf16 v[136:139], v[228:231], v[152:155], v[136:139]
    v_mfma_f32_16x16x32_bf16 v[140:143], v[228:231], v[160:163], v[140:143]
    v_xor_b32 v241, 64, v247
    ds_read_b64_tr_b16 v[224:225], v241 offset:8192
    ds_read_b64_tr_b16 v[226:227], v241 offset:9216
    s_waitcnt lgkmcnt(4)
    v_mfma_f32_16x16x32_bf16 v[48:51], v[216:219], v[148:151], v[48:51]
    v_mfma_f32_16x16x32_bf16 v[52:55], v[216:219], v[156:159], v[52:55]
    v_mfma_f32_16x16x32_bf16 v[56:59], v[216:219], v[164:167], v[56:59]
    v_xor_b32 v241, 64, v247
    ds_read_b64_tr_b16 v[228:229], v241 offset:8200
    ds_read_b64_tr_b16 v[230:231], v241 offset:9224
    s_waitcnt lgkmcnt(4)
    v_mfma_f32_16x16x32_bf16 v[60:63], v[220:223], v[148:151], v[60:63]
    v_mfma_f32_16x16x32_bf16 v[64:67], v[220:223], v[156:159], v[64:67]
    v_mfma_f32_16x16x32_bf16 v[68:71], v[220:223], v[164:167], v[68:71]
    v_xor_b32 v241, 128, v247
    ds_read_b64_tr_b16 v[216:217], v241 offset:8192
    ds_read_b64_tr_b16 v[218:219], v241 offset:9216
    s_waitcnt lgkmcnt(4)
    v_mfma_f32_16x16x32_bf16 v[72:75], v[224:227], v[148:151], v[72:75]
    v_mfma_f32_16x16x32_bf16 v[76:79], v[224:227], v[156:159], v[76:79]
    v_mfma_f32_16x16x32_bf16 v[80:83], v[224:227], v[164:167], v[80:83]
    v_xor_b32 v241, 128, v247
    ds_read_b64_tr_b16 v[220:221], v241 offset:8200
    ds_read_b64_tr_b16 v[222:223], v241 offset:9224
    s_waitcnt lgkmcnt(4)
    v_mfma_f32_16x16x32_bf16 v[84:87], v[228:231], v[148:151], v[84:87]
    v_mfma_f32_16x16x32_bf16 v[88:91], v[228:231], v[156:159], v[88:91]
    v_mfma_f32_16x16x32_bf16 v[92:95], v[228:231], v[164:167], v[92:95]
    v_xor_b32 v241, 192, v247
    ds_read_b64_tr_b16 v[224:225], v241 offset:8192
    ds_read_b64_tr_b16 v[226:227], v241 offset:9216
    s_waitcnt lgkmcnt(4)
    v_mfma_f32_16x16x32_bf16 v[96:99], v[216:219], v[148:151], v[96:99]
    v_mfma_f32_16x16x32_bf16 v[100:103], v[216:219], v[156:159], v[100:103]
    v_mfma_f32_16x16x32_bf16 v[104:107], v[216:219], v[164:167], v[104:107]
    v_xor_b32 v241, 192, v247
    ds_read_b64_tr_b16 v[228:229], v241 offset:8200
    ds_read_b64_tr_b16 v[230:231], v241 offset:9224
    s_waitcnt lgkmcnt(4)
    v_mfma_f32_16x16x32_bf16 v[108:111], v[220:223], v[148:151], v[108:111]
    v_mfma_f32_16x16x32_bf16 v[112:115], v[220:223], v[156:159], v[112:115]
    v_mfma_f32_16x16x32_bf16 v[116:119], v[220:223], v[164:167], v[116:119]
    s_waitcnt lgkmcnt(2)
    v_mfma_f32_16x16x32_bf16 v[120:123], v[224:227], v[148:151], v[120:123]
    v_mfma_f32_16x16x32_bf16 v[124:127], v[224:227], v[156:159], v[124:127]
    v_mfma_f32_16x16x32_bf16 v[128:131], v[224:227], v[164:167], v[128:131]
    s_waitcnt lgkmcnt(0)
    v_mfma_f32_16x16x32_bf16 v[132:135], v[228:231], v[148:151], v[132:135]
    v_mfma_f32_16x16x32_bf16 v[136:139], v[228:231], v[156:159], v[136:139]
    v_mfma_f32_16x16x32_bf16 v[140:143], v[228:231], v[164:167], v[140:143]
    s_barrier
    buffer_load_dwordx4 v[144:147], v248, s[20:23], s41 offen offset:768
    buffer_load_dwordx4 v[148:151], v248, s[20:23], s41 offen offset:832
    buffer_load_dwordx4 v[152:155], v248, s[20:23], s40 offen offset:768
    buffer_load_dwordx4 v[156:159], v248, s[20:23], s40 offen offset:832
    buffer_load_dwordx4 v[160:163], v248, s[20:23], s42 offen offset:768
    buffer_load_dwordx4 v[164:167], v248, s[20:23], s42 offen offset:832
    v_xor_b32 v241, 0, v247
    ds_read_b64_tr_b16 v[216:217], v241 offset:16384
    ds_read_b64_tr_b16 v[218:219], v241 offset:17408
    v_xor_b32 v241, 0, v247
    ds_read_b64_tr_b16 v[220:221], v241 offset:16392
    ds_read_b64_tr_b16 v[222:223], v241 offset:17416
    s_waitcnt vmcnt(6)
    v_xor_b32 v241, 64, v247
    ds_read_b64_tr_b16 v[224:225], v241 offset:16384
    ds_read_b64_tr_b16 v[226:227], v241 offset:17408
    s_waitcnt lgkmcnt(4)
    v_mfma_f32_16x16x32_bf16 v[48:51], v[216:219], v[168:171], v[48:51]
    v_mfma_f32_16x16x32_bf16 v[52:55], v[216:219], v[176:179], v[52:55]
    v_mfma_f32_16x16x32_bf16 v[56:59], v[216:219], v[184:187], v[56:59]
    v_xor_b32 v241, 64, v247
    ds_read_b64_tr_b16 v[228:229], v241 offset:16392
    ds_read_b64_tr_b16 v[230:231], v241 offset:17416
    s_waitcnt lgkmcnt(4)
    v_mfma_f32_16x16x32_bf16 v[60:63], v[220:223], v[168:171], v[60:63]
    v_mfma_f32_16x16x32_bf16 v[64:67], v[220:223], v[176:179], v[64:67]
    v_mfma_f32_16x16x32_bf16 v[68:71], v[220:223], v[184:187], v[68:71]
    v_xor_b32 v241, 128, v247
    ds_read_b64_tr_b16 v[216:217], v241 offset:16384
    ds_read_b64_tr_b16 v[218:219], v241 offset:17408
    s_waitcnt lgkmcnt(4)
    v_mfma_f32_16x16x32_bf16 v[72:75], v[224:227], v[168:171], v[72:75]
    v_mfma_f32_16x16x32_bf16 v[76:79], v[224:227], v[176:179], v[76:79]
    v_mfma_f32_16x16x32_bf16 v[80:83], v[224:227], v[184:187], v[80:83]
    v_xor_b32 v241, 128, v247
    ds_read_b64_tr_b16 v[220:221], v241 offset:16392
    ds_read_b64_tr_b16 v[222:223], v241 offset:17416
    s_waitcnt lgkmcnt(4)
    v_mfma_f32_16x16x32_bf16 v[84:87], v[228:231], v[168:171], v[84:87]
    v_mfma_f32_16x16x32_bf16 v[88:91], v[228:231], v[176:179], v[88:91]
    v_mfma_f32_16x16x32_bf16 v[92:95], v[228:231], v[184:187], v[92:95]
    v_xor_b32 v241, 192, v247
    ds_read_b64_tr_b16 v[224:225], v241 offset:16384
    ds_read_b64_tr_b16 v[226:227], v241 offset:17408
    s_waitcnt lgkmcnt(4)
    v_mfma_f32_16x16x32_bf16 v[96:99], v[216:219], v[168:171], v[96:99]
    v_mfma_f32_16x16x32_bf16 v[100:103], v[216:219], v[176:179], v[100:103]
    v_mfma_f32_16x16x32_bf16 v[104:107], v[216:219], v[184:187], v[104:107]
    v_xor_b32 v241, 192, v247
    ds_read_b64_tr_b16 v[228:229], v241 offset:16392
    ds_read_b64_tr_b16 v[230:231], v241 offset:17416
    s_waitcnt lgkmcnt(4)
    v_mfma_f32_16x16x32_bf16 v[108:111], v[220:223], v[168:171], v[108:111]
    v_mfma_f32_16x16x32_bf16 v[112:115], v[220:223], v[176:179], v[112:115]
    v_mfma_f32_16x16x32_bf16 v[116:119], v[220:223], v[184:187], v[116:119]
    v_xor_b32 v241, 0, v247
    ds_read_b64_tr_b16 v[216:217], v241 offset:24576
    ds_read_b64_tr_b16 v[218:219], v241 offset:25600
    s_waitcnt lgkmcnt(4)
    v_mfma_f32_16x16x32_bf16 v[120:123], v[224:227], v[168:171], v[120:123]
    v_mfma_f32_16x16x32_bf16 v[124:127], v[224:227], v[176:179], v[124:127]
    v_mfma_f32_16x16x32_bf16 v[128:131], v[224:227], v[184:187], v[128:131]
    v_xor_b32 v241, 0, v247
    ds_read_b64_tr_b16 v[220:221], v241 offset:24584
    ds_read_b64_tr_b16 v[222:223], v241 offset:25608
    s_waitcnt lgkmcnt(4)
    v_mfma_f32_16x16x32_bf16 v[132:135], v[228:231], v[168:171], v[132:135]
    v_mfma_f32_16x16x32_bf16 v[136:139], v[228:231], v[176:179], v[136:139]
    v_mfma_f32_16x16x32_bf16 v[140:143], v[228:231], v[184:187], v[140:143]
    v_xor_b32 v241, 64, v247
    ds_read_b64_tr_b16 v[224:225], v241 offset:24576
    ds_read_b64_tr_b16 v[226:227], v241 offset:25600
    s_waitcnt lgkmcnt(4)
    v_mfma_f32_16x16x32_bf16 v[48:51], v[216:219], v[172:175], v[48:51]
    v_mfma_f32_16x16x32_bf16 v[52:55], v[216:219], v[180:183], v[52:55]
    v_mfma_f32_16x16x32_bf16 v[56:59], v[216:219], v[188:191], v[56:59]
    v_xor_b32 v241, 64, v247
    ds_read_b64_tr_b16 v[228:229], v241 offset:24584
    ds_read_b64_tr_b16 v[230:231], v241 offset:25608
    s_waitcnt lgkmcnt(4)
    v_mfma_f32_16x16x32_bf16 v[60:63], v[220:223], v[172:175], v[60:63]
    v_mfma_f32_16x16x32_bf16 v[64:67], v[220:223], v[180:183], v[64:67]
    v_mfma_f32_16x16x32_bf16 v[68:71], v[220:223], v[188:191], v[68:71]
    v_xor_b32 v241, 128, v247
    ds_read_b64_tr_b16 v[216:217], v241 offset:24576
    ds_read_b64_tr_b16 v[218:219], v241 offset:25600
    s_waitcnt lgkmcnt(4)
    v_mfma_f32_16x16x32_bf16 v[72:75], v[224:227], v[172:175], v[72:75]
    v_mfma_f32_16x16x32_bf16 v[76:79], v[224:227], v[180:183], v[76:79]
    v_mfma_f32_16x16x32_bf16 v[80:83], v[224:227], v[188:191], v[80:83]
    v_xor_b32 v241, 128, v247
    ds_read_b64_tr_b16 v[220:221], v241 offset:24584
    ds_read_b64_tr_b16 v[222:223], v241 offset:25608
    s_waitcnt lgkmcnt(4)
    v_mfma_f32_16x16x32_bf16 v[84:87], v[228:231], v[172:175], v[84:87]
    v_mfma_f32_16x16x32_bf16 v[88:91], v[228:231], v[180:183], v[88:91]
    v_mfma_f32_16x16x32_bf16 v[92:95], v[228:231], v[188:191], v[92:95]
    v_xor_b32 v241, 192, v247
    ds_read_b64_tr_b16 v[224:225], v241 offset:24576
    ds_read_b64_tr_b16 v[226:227], v241 offset:25600
    s_waitcnt lgkmcnt(4)
    v_mfma_f32_16x16x32_bf16 v[96:99], v[216:219], v[172:175], v[96:99]
    v_mfma_f32_16x16x32_bf16 v[100:103], v[216:219], v[180:183], v[100:103]
    v_mfma_f32_16x16x32_bf16 v[104:107], v[216:219], v[188:191], v[104:107]
    v_xor_b32 v241, 192, v247
    ds_read_b64_tr_b16 v[228:229], v241 offset:24584
    ds_read_b64_tr_b16 v[230:231], v241 offset:25608
    s_waitcnt lgkmcnt(4)
    v_mfma_f32_16x16x32_bf16 v[108:111], v[220:223], v[172:175], v[108:111]
    v_mfma_f32_16x16x32_bf16 v[112:115], v[220:223], v[180:183], v[112:115]
    v_mfma_f32_16x16x32_bf16 v[116:119], v[220:223], v[188:191], v[116:119]
    s_waitcnt lgkmcnt(2)
    v_mfma_f32_16x16x32_bf16 v[120:123], v[224:227], v[172:175], v[120:123]
    v_mfma_f32_16x16x32_bf16 v[124:127], v[224:227], v[180:183], v[124:127]
    v_mfma_f32_16x16x32_bf16 v[128:131], v[224:227], v[188:191], v[128:131]
    s_waitcnt lgkmcnt(0)
    v_mfma_f32_16x16x32_bf16 v[132:135], v[228:231], v[172:175], v[132:135]
    v_mfma_f32_16x16x32_bf16 v[136:139], v[228:231], v[180:183], v[136:139]
    v_mfma_f32_16x16x32_bf16 v[140:143], v[228:231], v[188:191], v[140:143]
    s_barrier
    buffer_load_dwordx4 v[168:171], v248, s[20:23], s41 offen offset:896
    buffer_load_dwordx4 v[172:175], v248, s[20:23], s41 offen offset:960
    buffer_load_dwordx4 v[176:179], v248, s[20:23], s40 offen offset:896
    buffer_load_dwordx4 v[180:183], v248, s[20:23], s40 offen offset:960
    buffer_load_dwordx4 v[184:187], v248, s[20:23], s42 offen offset:896
    buffer_load_dwordx4 v[188:191], v248, s[20:23], s42 offen offset:960
    v_xor_b32 v241, 0, v247
    ds_read_b64_tr_b16 v[216:217], v241 offset:32768
    ds_read_b64_tr_b16 v[218:219], v241 offset:33792
    v_xor_b32 v241, 0, v247
    ds_read_b64_tr_b16 v[220:221], v241 offset:32776
    ds_read_b64_tr_b16 v[222:223], v241 offset:33800
    s_waitcnt vmcnt(6)
    v_xor_b32 v241, 64, v247
    ds_read_b64_tr_b16 v[224:225], v241 offset:32768
    ds_read_b64_tr_b16 v[226:227], v241 offset:33792
    s_waitcnt lgkmcnt(4)
    v_mfma_f32_16x16x32_bf16 v[48:51], v[216:219], v[144:147], v[48:51]
    v_mfma_f32_16x16x32_bf16 v[52:55], v[216:219], v[152:155], v[52:55]
    v_mfma_f32_16x16x32_bf16 v[56:59], v[216:219], v[160:163], v[56:59]
    v_xor_b32 v241, 64, v247
    ds_read_b64_tr_b16 v[228:229], v241 offset:32776
    ds_read_b64_tr_b16 v[230:231], v241 offset:33800
    s_waitcnt lgkmcnt(4)
    v_mfma_f32_16x16x32_bf16 v[60:63], v[220:223], v[144:147], v[60:63]
    v_mfma_f32_16x16x32_bf16 v[64:67], v[220:223], v[152:155], v[64:67]
    v_mfma_f32_16x16x32_bf16 v[68:71], v[220:223], v[160:163], v[68:71]
    v_xor_b32 v241, 128, v247
    ds_read_b64_tr_b16 v[216:217], v241 offset:32768
    ds_read_b64_tr_b16 v[218:219], v241 offset:33792
    s_waitcnt lgkmcnt(4)
    v_mfma_f32_16x16x32_bf16 v[72:75], v[224:227], v[144:147], v[72:75]
    v_mfma_f32_16x16x32_bf16 v[76:79], v[224:227], v[152:155], v[76:79]
    v_mfma_f32_16x16x32_bf16 v[80:83], v[224:227], v[160:163], v[80:83]
    v_xor_b32 v241, 128, v247
    ds_read_b64_tr_b16 v[220:221], v241 offset:32776
    ds_read_b64_tr_b16 v[222:223], v241 offset:33800
    s_waitcnt lgkmcnt(4)
    v_mfma_f32_16x16x32_bf16 v[84:87], v[228:231], v[144:147], v[84:87]
    v_mfma_f32_16x16x32_bf16 v[88:91], v[228:231], v[152:155], v[88:91]
    v_mfma_f32_16x16x32_bf16 v[92:95], v[228:231], v[160:163], v[92:95]
    v_xor_b32 v241, 192, v247
    ds_read_b64_tr_b16 v[224:225], v241 offset:32768
    ds_read_b64_tr_b16 v[226:227], v241 offset:33792
    s_waitcnt lgkmcnt(4)
    v_mfma_f32_16x16x32_bf16 v[96:99], v[216:219], v[144:147], v[96:99]
    v_mfma_f32_16x16x32_bf16 v[100:103], v[216:219], v[152:155], v[100:103]
    v_mfma_f32_16x16x32_bf16 v[104:107], v[216:219], v[160:163], v[104:107]
    v_xor_b32 v241, 192, v247
    ds_read_b64_tr_b16 v[228:229], v241 offset:32776
    ds_read_b64_tr_b16 v[230:231], v241 offset:33800
    s_waitcnt lgkmcnt(4)
    v_mfma_f32_16x16x32_bf16 v[108:111], v[220:223], v[144:147], v[108:111]
    v_mfma_f32_16x16x32_bf16 v[112:115], v[220:223], v[152:155], v[112:115]
    v_mfma_f32_16x16x32_bf16 v[116:119], v[220:223], v[160:163], v[116:119]
    v_xor_b32 v241, 0, v247
    ds_read_b64_tr_b16 v[216:217], v241 offset:40960
    ds_read_b64_tr_b16 v[218:219], v241 offset:41984
    s_waitcnt lgkmcnt(4)
    v_mfma_f32_16x16x32_bf16 v[120:123], v[224:227], v[144:147], v[120:123]
    v_mfma_f32_16x16x32_bf16 v[124:127], v[224:227], v[152:155], v[124:127]
    v_mfma_f32_16x16x32_bf16 v[128:131], v[224:227], v[160:163], v[128:131]
    v_xor_b32 v241, 0, v247
    ds_read_b64_tr_b16 v[220:221], v241 offset:40968
    ds_read_b64_tr_b16 v[222:223], v241 offset:41992
    s_waitcnt lgkmcnt(4)
    v_mfma_f32_16x16x32_bf16 v[132:135], v[228:231], v[144:147], v[132:135]
    v_mfma_f32_16x16x32_bf16 v[136:139], v[228:231], v[152:155], v[136:139]
    v_mfma_f32_16x16x32_bf16 v[140:143], v[228:231], v[160:163], v[140:143]
    v_xor_b32 v241, 64, v247
    ds_read_b64_tr_b16 v[224:225], v241 offset:40960
    ds_read_b64_tr_b16 v[226:227], v241 offset:41984
    s_waitcnt lgkmcnt(4)
    v_mfma_f32_16x16x32_bf16 v[48:51], v[216:219], v[148:151], v[48:51]
    v_mfma_f32_16x16x32_bf16 v[52:55], v[216:219], v[156:159], v[52:55]
    v_mfma_f32_16x16x32_bf16 v[56:59], v[216:219], v[164:167], v[56:59]
    v_xor_b32 v241, 64, v247
    ds_read_b64_tr_b16 v[228:229], v241 offset:40968
    ds_read_b64_tr_b16 v[230:231], v241 offset:41992
    s_waitcnt lgkmcnt(4)
    v_mfma_f32_16x16x32_bf16 v[60:63], v[220:223], v[148:151], v[60:63]
    v_mfma_f32_16x16x32_bf16 v[64:67], v[220:223], v[156:159], v[64:67]
    v_mfma_f32_16x16x32_bf16 v[68:71], v[220:223], v[164:167], v[68:71]
    v_xor_b32 v241, 128, v247
    ds_read_b64_tr_b16 v[216:217], v241 offset:40960
    ds_read_b64_tr_b16 v[218:219], v241 offset:41984
    s_waitcnt lgkmcnt(4)
    v_mfma_f32_16x16x32_bf16 v[72:75], v[224:227], v[148:151], v[72:75]
    v_mfma_f32_16x16x32_bf16 v[76:79], v[224:227], v[156:159], v[76:79]
    v_mfma_f32_16x16x32_bf16 v[80:83], v[224:227], v[164:167], v[80:83]
    v_xor_b32 v241, 128, v247
    ds_read_b64_tr_b16 v[220:221], v241 offset:40968
    ds_read_b64_tr_b16 v[222:223], v241 offset:41992
    s_waitcnt lgkmcnt(4)
    v_mfma_f32_16x16x32_bf16 v[84:87], v[228:231], v[148:151], v[84:87]
    v_mfma_f32_16x16x32_bf16 v[88:91], v[228:231], v[156:159], v[88:91]
    v_mfma_f32_16x16x32_bf16 v[92:95], v[228:231], v[164:167], v[92:95]
    v_xor_b32 v241, 192, v247
    ds_read_b64_tr_b16 v[224:225], v241 offset:40960
    ds_read_b64_tr_b16 v[226:227], v241 offset:41984
    s_waitcnt lgkmcnt(4)
    v_mfma_f32_16x16x32_bf16 v[96:99], v[216:219], v[148:151], v[96:99]
    v_mfma_f32_16x16x32_bf16 v[100:103], v[216:219], v[156:159], v[100:103]
    v_mfma_f32_16x16x32_bf16 v[104:107], v[216:219], v[164:167], v[104:107]
    v_xor_b32 v241, 192, v247
    ds_read_b64_tr_b16 v[228:229], v241 offset:40968
    ds_read_b64_tr_b16 v[230:231], v241 offset:41992
    s_waitcnt lgkmcnt(4)
    v_mfma_f32_16x16x32_bf16 v[108:111], v[220:223], v[148:151], v[108:111]
    v_mfma_f32_16x16x32_bf16 v[112:115], v[220:223], v[156:159], v[112:115]
    v_mfma_f32_16x16x32_bf16 v[116:119], v[220:223], v[164:167], v[116:119]
    s_waitcnt lgkmcnt(2)
    v_mfma_f32_16x16x32_bf16 v[120:123], v[224:227], v[148:151], v[120:123]
    v_mfma_f32_16x16x32_bf16 v[124:127], v[224:227], v[156:159], v[124:127]
    v_mfma_f32_16x16x32_bf16 v[128:131], v[224:227], v[164:167], v[128:131]
    s_waitcnt lgkmcnt(0)
    v_mfma_f32_16x16x32_bf16 v[132:135], v[228:231], v[148:151], v[132:135]
    v_mfma_f32_16x16x32_bf16 v[136:139], v[228:231], v[156:159], v[136:139]
    v_mfma_f32_16x16x32_bf16 v[140:143], v[228:231], v[164:167], v[140:143]
    s_barrier
    v_xor_b32 v241, 0, v247
    ds_read_b64_tr_b16 v[216:217], v241 offset:49152
    ds_read_b64_tr_b16 v[218:219], v241 offset:50176
    v_xor_b32 v241, 0, v247
    ds_read_b64_tr_b16 v[220:221], v241 offset:49160
    ds_read_b64_tr_b16 v[222:223], v241 offset:50184
    s_waitcnt vmcnt(0)
    v_xor_b32 v241, 64, v247
    ds_read_b64_tr_b16 v[224:225], v241 offset:49152
    ds_read_b64_tr_b16 v[226:227], v241 offset:50176
    s_waitcnt lgkmcnt(4)
    v_mfma_f32_16x16x32_bf16 v[48:51], v[216:219], v[168:171], v[48:51]
    v_mfma_f32_16x16x32_bf16 v[52:55], v[216:219], v[176:179], v[52:55]
    v_mfma_f32_16x16x32_bf16 v[56:59], v[216:219], v[184:187], v[56:59]
    v_xor_b32 v241, 64, v247
    ds_read_b64_tr_b16 v[228:229], v241 offset:49160
    ds_read_b64_tr_b16 v[230:231], v241 offset:50184
    s_waitcnt lgkmcnt(4)
    v_mfma_f32_16x16x32_bf16 v[60:63], v[220:223], v[168:171], v[60:63]
    v_mfma_f32_16x16x32_bf16 v[64:67], v[220:223], v[176:179], v[64:67]
    v_mfma_f32_16x16x32_bf16 v[68:71], v[220:223], v[184:187], v[68:71]
    v_xor_b32 v241, 128, v247
    ds_read_b64_tr_b16 v[216:217], v241 offset:49152
    ds_read_b64_tr_b16 v[218:219], v241 offset:50176
    s_waitcnt lgkmcnt(4)
    v_mfma_f32_16x16x32_bf16 v[72:75], v[224:227], v[168:171], v[72:75]
    v_mfma_f32_16x16x32_bf16 v[76:79], v[224:227], v[176:179], v[76:79]
    v_mfma_f32_16x16x32_bf16 v[80:83], v[224:227], v[184:187], v[80:83]
    v_xor_b32 v241, 128, v247
    ds_read_b64_tr_b16 v[220:221], v241 offset:49160
    ds_read_b64_tr_b16 v[222:223], v241 offset:50184
    s_waitcnt lgkmcnt(4)
    v_mfma_f32_16x16x32_bf16 v[84:87], v[228:231], v[168:171], v[84:87]
    v_mfma_f32_16x16x32_bf16 v[88:91], v[228:231], v[176:179], v[88:91]
    v_mfma_f32_16x16x32_bf16 v[92:95], v[228:231], v[184:187], v[92:95]
    v_xor_b32 v241, 192, v247
    ds_read_b64_tr_b16 v[224:225], v241 offset:49152
    ds_read_b64_tr_b16 v[226:227], v241 offset:50176
    s_waitcnt lgkmcnt(4)
    v_mfma_f32_16x16x32_bf16 v[96:99], v[216:219], v[168:171], v[96:99]
    v_mfma_f32_16x16x32_bf16 v[100:103], v[216:219], v[176:179], v[100:103]
    v_mfma_f32_16x16x32_bf16 v[104:107], v[216:219], v[184:187], v[104:107]
    v_xor_b32 v241, 192, v247
    ds_read_b64_tr_b16 v[228:229], v241 offset:49160
    ds_read_b64_tr_b16 v[230:231], v241 offset:50184
    s_waitcnt lgkmcnt(4)
    v_mfma_f32_16x16x32_bf16 v[108:111], v[220:223], v[168:171], v[108:111]
    v_mfma_f32_16x16x32_bf16 v[112:115], v[220:223], v[176:179], v[112:115]
    v_mfma_f32_16x16x32_bf16 v[116:119], v[220:223], v[184:187], v[116:119]
    v_xor_b32 v241, 0, v247
    ds_read_b64_tr_b16 v[216:217], v241 offset:57344
    ds_read_b64_tr_b16 v[218:219], v241 offset:58368
    s_waitcnt lgkmcnt(4)
    v_mfma_f32_16x16x32_bf16 v[120:123], v[224:227], v[168:171], v[120:123]
    v_mfma_f32_16x16x32_bf16 v[124:127], v[224:227], v[176:179], v[124:127]
    v_mfma_f32_16x16x32_bf16 v[128:131], v[224:227], v[184:187], v[128:131]
    v_xor_b32 v241, 0, v247
    ds_read_b64_tr_b16 v[220:221], v241 offset:57352
    ds_read_b64_tr_b16 v[222:223], v241 offset:58376
    s_waitcnt lgkmcnt(4)
    v_mfma_f32_16x16x32_bf16 v[132:135], v[228:231], v[168:171], v[132:135]
    v_mfma_f32_16x16x32_bf16 v[136:139], v[228:231], v[176:179], v[136:139]
    v_mfma_f32_16x16x32_bf16 v[140:143], v[228:231], v[184:187], v[140:143]
    v_xor_b32 v241, 64, v247
    ds_read_b64_tr_b16 v[224:225], v241 offset:57344
    ds_read_b64_tr_b16 v[226:227], v241 offset:58368
    s_waitcnt lgkmcnt(4)
    v_mfma_f32_16x16x32_bf16 v[48:51], v[216:219], v[172:175], v[48:51]
    v_mfma_f32_16x16x32_bf16 v[52:55], v[216:219], v[180:183], v[52:55]
    v_mfma_f32_16x16x32_bf16 v[56:59], v[216:219], v[188:191], v[56:59]
    v_xor_b32 v241, 64, v247
    ds_read_b64_tr_b16 v[228:229], v241 offset:57352
    ds_read_b64_tr_b16 v[230:231], v241 offset:58376
    s_waitcnt lgkmcnt(4)
    v_mfma_f32_16x16x32_bf16 v[60:63], v[220:223], v[172:175], v[60:63]
    v_mfma_f32_16x16x32_bf16 v[64:67], v[220:223], v[180:183], v[64:67]
    v_mfma_f32_16x16x32_bf16 v[68:71], v[220:223], v[188:191], v[68:71]
    v_xor_b32 v241, 128, v247
    ds_read_b64_tr_b16 v[216:217], v241 offset:57344
    ds_read_b64_tr_b16 v[218:219], v241 offset:58368
    s_waitcnt lgkmcnt(4)
    v_mfma_f32_16x16x32_bf16 v[72:75], v[224:227], v[172:175], v[72:75]
    v_mfma_f32_16x16x32_bf16 v[76:79], v[224:227], v[180:183], v[76:79]
    v_mfma_f32_16x16x32_bf16 v[80:83], v[224:227], v[188:191], v[80:83]
    v_xor_b32 v241, 128, v247
    ds_read_b64_tr_b16 v[220:221], v241 offset:57352
    ds_read_b64_tr_b16 v[222:223], v241 offset:58376
    s_waitcnt lgkmcnt(4)
    v_mfma_f32_16x16x32_bf16 v[84:87], v[228:231], v[172:175], v[84:87]
    v_mfma_f32_16x16x32_bf16 v[88:91], v[228:231], v[180:183], v[88:91]
    v_mfma_f32_16x16x32_bf16 v[92:95], v[228:231], v[188:191], v[92:95]
    v_xor_b32 v241, 192, v247
    ds_read_b64_tr_b16 v[224:225], v241 offset:57344
    ds_read_b64_tr_b16 v[226:227], v241 offset:58368
    s_waitcnt lgkmcnt(4)
    v_mfma_f32_16x16x32_bf16 v[96:99], v[216:219], v[172:175], v[96:99]
    v_mfma_f32_16x16x32_bf16 v[100:103], v[216:219], v[180:183], v[100:103]
    v_mfma_f32_16x16x32_bf16 v[104:107], v[216:219], v[188:191], v[104:107]
    v_xor_b32 v241, 192, v247
    ds_read_b64_tr_b16 v[228:229], v241 offset:57352
    ds_read_b64_tr_b16 v[230:231], v241 offset:58376
    s_waitcnt lgkmcnt(4)
    v_mfma_f32_16x16x32_bf16 v[108:111], v[220:223], v[172:175], v[108:111]
    v_mfma_f32_16x16x32_bf16 v[112:115], v[220:223], v[180:183], v[112:115]
    v_mfma_f32_16x16x32_bf16 v[116:119], v[220:223], v[188:191], v[116:119]
    s_waitcnt lgkmcnt(2)
    v_mfma_f32_16x16x32_bf16 v[120:123], v[224:227], v[172:175], v[120:123]
    v_mfma_f32_16x16x32_bf16 v[124:127], v[224:227], v[180:183], v[124:127]
    v_mfma_f32_16x16x32_bf16 v[128:131], v[224:227], v[188:191], v[128:131]
    s_waitcnt lgkmcnt(0)
    v_mfma_f32_16x16x32_bf16 v[132:135], v[228:231], v[172:175], v[132:135]
    v_mfma_f32_16x16x32_bf16 v[136:139], v[228:231], v[180:183], v[136:139]
    v_mfma_f32_16x16x32_bf16 v[140:143], v[228:231], v[188:191], v[140:143]
    s_nop 7
    s_nop 1
    v_cvt_pk_bf16_f32 v0, v48, v49
    v_cvt_pk_bf16_f32 v1, v50, v51
    v_cvt_pk_bf16_f32 v2, v60, v61
    v_cvt_pk_bf16_f32 v3, v62, v63
    v_cvt_pk_bf16_f32 v4, v72, v73
    v_cvt_pk_bf16_f32 v5, v74, v75
    v_cvt_pk_bf16_f32 v6, v84, v85
    v_cvt_pk_bf16_f32 v7, v86, v87
    v_cvt_pk_bf16_f32 v8, v96, v97
    v_cvt_pk_bf16_f32 v9, v98, v99
    v_cvt_pk_bf16_f32 v10, v108, v109
    v_cvt_pk_bf16_f32 v11, v110, v111
    v_cvt_pk_bf16_f32 v12, v120, v121
    v_cvt_pk_bf16_f32 v13, v122, v123
    v_cvt_pk_bf16_f32 v14, v132, v133
    v_cvt_pk_bf16_f32 v15, v134, v135
    v_cvt_pk_bf16_f32 v16, v52, v53
    v_cvt_pk_bf16_f32 v17, v54, v55
    v_cvt_pk_bf16_f32 v18, v64, v65
    v_cvt_pk_bf16_f32 v19, v66, v67
    v_cvt_pk_bf16_f32 v20, v76, v77
    v_cvt_pk_bf16_f32 v21, v78, v79
    v_cvt_pk_bf16_f32 v22, v88, v89
    v_cvt_pk_bf16_f32 v23, v90, v91
    v_cvt_pk_bf16_f32 v24, v100, v101
    v_cvt_pk_bf16_f32 v25, v102, v103
    v_cvt_pk_bf16_f32 v26, v112, v113
    v_cvt_pk_bf16_f32 v27, v114, v115
    v_cvt_pk_bf16_f32 v28, v124, v125
    v_cvt_pk_bf16_f32 v29, v126, v127
    v_cvt_pk_bf16_f32 v30, v136, v137
    v_cvt_pk_bf16_f32 v31, v138, v139
    v_cvt_pk_bf16_f32 v32, v56, v57
    v_cvt_pk_bf16_f32 v33, v58, v59
    v_cvt_pk_bf16_f32 v34, v68, v69
    v_cvt_pk_bf16_f32 v35, v70, v71
    v_cvt_pk_bf16_f32 v36, v80, v81
    v_cvt_pk_bf16_f32 v37, v82, v83
    v_cvt_pk_bf16_f32 v38, v92, v93
    v_cvt_pk_bf16_f32 v39, v94, v95
    v_cvt_pk_bf16_f32 v40, v104, v105
    v_cvt_pk_bf16_f32 v41, v106, v107
    v_cvt_pk_bf16_f32 v42, v116, v117
    v_cvt_pk_bf16_f32 v43, v118, v119
    v_cvt_pk_bf16_f32 v44, v128, v129
    v_cvt_pk_bf16_f32 v45, v130, v131
    v_cvt_pk_bf16_f32 v46, v140, v141
    v_cvt_pk_bf16_f32 v47, v142, v143
    v_mov_b32 v48, 0
    v_mov_b32 v49, 0
    v_mov_b32 v50, 0
    v_mov_b32 v51, 0
    v_mov_b32 v52, 0
    v_mov_b32 v53, 0
    v_mov_b32 v54, 0
    v_mov_b32 v55, 0
    v_mov_b32 v56, 0
    v_mov_b32 v57, 0
    v_mov_b32 v58, 0
    v_mov_b32 v59, 0
    v_mov_b32 v60, 0
    v_mov_b32 v61, 0
    v_mov_b32 v62, 0
    v_mov_b32 v63, 0
    v_mov_b32 v64, 0
    v_mov_b32 v65, 0
    v_mov_b32 v66, 0
    v_mov_b32 v67, 0
    v_mov_b32 v68, 0
    v_mov_b32 v69, 0
    v_mov_b32 v70, 0
    v_mov_b32 v71, 0
    v_mov_b32 v72, 0
    v_mov_b32 v73, 0
    v_mov_b32 v74, 0
    v_mov_b32 v75, 0
    v_mov_b32 v76, 0
    v_mov_b32 v77, 0
    v_mov_b32 v78, 0
    v_mov_b32 v79, 0
    v_mov_b32 v80, 0
    v_mov_b32 v81, 0
    v_mov_b32 v82, 0
    v_mov_b32 v83, 0
    v_mov_b32 v84, 0
    v_mov_b32 v85, 0
    v_mov_b32 v86, 0
    v_mov_b32 v87, 0
    v_mov_b32 v88, 0
    v_mov_b32 v89, 0
    v_mov_b32 v90, 0
    v_mov_b32 v91, 0
    v_mov_b32 v92, 0
    v_mov_b32 v93, 0
    v_mov_b32 v94, 0
    v_mov_b32 v95, 0
    v_mov_b32 v96, 0
    v_mov_b32 v97, 0
    v_mov_b32 v98, 0
    v_mov_b32 v99, 0
    v_mov_b32 v100, 0
    v_mov_b32 v101, 0
    v_mov_b32 v102, 0
    v_mov_b32 v103, 0
    v_mov_b32 v104, 0
    v_mov_b32 v105, 0
    v_mov_b32 v106, 0
    v_mov_b32 v107, 0
    v_mov_b32 v108, 0
    v_mov_b32 v109, 0
    v_mov_b32 v110, 0
    v_mov_b32 v111, 0
    v_mov_b32 v112, 0
    v_mov_b32 v113, 0
    v_mov_b32 v114, 0
    v_mov_b32 v115, 0
    v_mov_b32 v116, 0
    v_mov_b32 v117, 0
    v_mov_b32 v118, 0
    v_mov_b32 v119, 0
    v_mov_b32 v120, 0
    v_mov_b32 v121, 0
    v_mov_b32 v122, 0
    v_mov_b32 v123, 0
    v_mov_b32 v124, 0
    v_mov_b32 v125, 0
    v_mov_b32 v126, 0
    v_mov_b32 v127, 0
    v_mov_b32 v128, 0
    v_mov_b32 v129, 0
    v_mov_b32 v130, 0
    v_mov_b32 v131, 0
    v_mov_b32 v132, 0
    v_mov_b32 v133, 0
    v_mov_b32 v134, 0
    v_mov_b32 v135, 0
    v_mov_b32 v136, 0
    v_mov_b32 v137, 0
    v_mov_b32 v138, 0
    v_mov_b32 v139, 0
    v_mov_b32 v140, 0
    v_mov_b32 v141, 0
    v_mov_b32 v142, 0
    v_mov_b32 v143, 0
    v_mov_b32 v232, 0xff800000
    v_mov_b32 v235, 0
    v_mov_b32 v233, 0xff800000
    v_mov_b32 v236, 0
    v_mov_b32 v234, 0xff800000
    v_mov_b32 v237, 0
    s_mov_b32 s43, 1040356334
    s_mov_b32 s44, 4
K1_LOOP:
    s_barrier
    v_mov_b32 v144, 0
    v_mov_b32 v145, 0
    v_mov_b32 v146, 0
    v_mov_b32 v147, 0
    v_mov_b32 v148, 0
    v_mov_b32 v149, 0
    v_mov_b32 v150, 0
    v_mov_b32 v151, 0
    v_mov_b32 v152, 0
    v_mov_b32 v153, 0
    v_mov_b32 v154, 0
    v_mov_b32 v155, 0
    v_mov_b32 v156, 0
    v_mov_b32 v157, 0
    v_mov_b32 v158, 0
    v_mov_b32 v159, 0
    v_mov_b32 v160, 0
    v_mov_b32 v161, 0
    v_mov_b32 v162, 0
    v_mov_b32 v163, 0
    v_mov_b32 v164, 0
    v_mov_b32 v165, 0
    v_mov_b32 v166, 0
    v_mov_b32 v167, 0
    v_mov_b32 v168, 0
    v_mov_b32 v169, 0
    v_mov_b32 v170, 0
    v_mov_b32 v171, 0
    v_mov_b32 v172, 0
    v_mov_b32 v173, 0
    v_mov_b32 v174, 0
    v_mov_b32 v175, 0
    v_mov_b32 v176, 0
    v_mov_b32 v177, 0
    v_mov_b32 v178, 0
    v_mov_b32 v179, 0
    v_mov_b32 v180, 0
    v_mov_b32 v181, 0
    v_mov_b32 v182, 0
    v_mov_b32 v183, 0
    v_mov_b32 v184, 0
    v_mov_b32 v185, 0
    v_mov_b32 v186, 0
    v_mov_b32 v187, 0
    v_mov_b32 v188, 0
    v_mov_b32 v189, 0
    v_mov_b32 v190, 0
    v_mov_b32 v191, 0
    v_xor_b32 v241, 0, v245
    ds_read_b128 v[216:219], v241 offset:0
    v_xor_b32 v241, 64, v245
    ds_read_b128 v[220:223], v241 offset:0
    v_xor_b32 v241, 128, v245
    ds_read_b128 v[224:227], v241 offset:0
    s_waitcnt lgkmcnt(2)
    v_mfma_f32_16x16x32_bf16 v[144:147], v[216:219], v[0:3], v[144:147]
    v_mfma_f32_16x16x32_bf16 v[148:151], v[216:219], v[16:19], v[148:151]
    v_mfma_f32_16x16x32_bf16 v[152:155], v[216:219], v[32:35], v[152:155]
    v_xor_b32 v241, 192, v245
    ds_read_b128 v[228:231], v241 offset:0
    s_waitcnt lgkmcnt(2)
    v_mfma_f32_16x16x32_bf16 v[144:147], v[220:223], v[4:7], v[144:147]
    v_mfma_f32_16x16x32_bf16 v[148:151], v[220:223], v[20:23], v[148:151]
    v_mfma_f32_16x16x32_bf16 v[152:155], v[220:223], v[36:39], v[152:155]
    v_xor_b32 v241, 0, v245
    ds_read_b128 v[216:219], v241 offset:4096
    s_waitcnt lgkmcnt(2)
    v_mfma_f32_16x16x32_bf16 v[144:147], v[224:227], v[8:11], v[144:147]
    v_mfma_f32_16x16x32_bf16 v[148:151], v[224:227], v[24:27], v[148:151]
    v_mfma_f32_16x16x32_bf16 v[152:155], v[224:227], v[40:43], v[152:155]
    v_xor_b32 v241, 64, v245
    ds_read_b128 v[220:223], v241 offset:4096
    s_waitcnt lgkmcnt(2)
    v_mfma_f32_16x16x32_bf16 v[144:147], v[228:231], v[12:15], v[144:147]
    v_mfma_f32_16x16x32_bf16 v[148:151], v[228:231], v[28:31], v[148:151]
    v_mfma_f32_16x16x32_bf16 v[152:155], v[228:231], v[44:47], v[152:155]
    v_xor_b32 v241, 128, v245
    ds_read_b128 v[224:227], v241 offset:4096
    s_waitcnt lgkmcnt(2)
    v_mfma_f32_16x16x32_bf16 v[156:159], v[216:219], v[0:3], v[156:159]
    v_mfma_f32_16x16x32_bf16 v[160:163], v[216:219], v[16:19], v[160:163]
    v_mfma_f32_16x16x32_bf16 v[164:167], v[216:219], v[32:35], v[164:167]
    v_xor_b32 v241, 192, v245
    ds_read_b128 v[228:231], v241 offset:4096
    s_waitcnt lgkmcnt(2)
    v_mfma_f32_16x16x32_bf16 v[156:159], v[220:223], v[4:7], v[156:159]
    v_mfma_f32_16x16x32_bf16 v[160:163], v[220:223], v[20:23], v[160:163]
    v_mfma_f32_16x16x32_bf16 v[164:167], v[220:223], v[36:39], v[164:167]
    v_xor_b32 v241, 0, v245
    ds_read_b128 v[216:219], v241 offset:8192
    s_waitcnt lgkmcnt(2)
    v_mfma_f32_16x16x32_bf16 v[156:159], v[224:227], v[8:11], v[156:159]
    v_mfma_f32_16x16x32_bf16 v[160:163], v[224:227], v[24:27], v[160:163]
    v_mfma_f32_16x16x32_bf16 v[164:167], v[224:227], v[40:43], v[164:167]
    v_xor_b32 v241, 64, v245
    ds_read_b128 v[220:223], v241 offset:8192
    s_waitcnt lgkmcnt(2)
    v_mfma_f32_16x16x32_bf16 v[156:159], v[228:231], v[12:15], v[156:159]
    v_mfma_f32_16x16x32_bf16 v[160:163], v[228:231], v[28:31], v[160:163]
    v_mfma_f32_16x16x32_bf16 v[164:167], v[228:231], v[44:47], v[164:167]
    v_xor_b32 v241, 128, v245
    ds_read_b128 v[224:227], v241 offset:8192
    s_waitcnt lgkmcnt(2)
    v_mfma_f32_16x16x32_bf16 v[168:171], v[216:219], v[0:3], v[168:171]
    v_mfma_f32_16x16x32_bf16 v[172:175], v[216:219], v[16:19], v[172:175]
    v_mfma_f32_16x16x32_bf16 v[176:179], v[216:219], v[32:35], v[176:179]
    v_xor_b32 v241, 192, v245
    ds_read_b128 v[228:231], v241 offset:8192
    s_waitcnt lgkmcnt(2)
    v_mfma_f32_16x16x32_bf16 v[168:171], v[220:223], v[4:7], v[168:171]
    v_mfma_f32_16x16x32_bf16 v[172:175], v[220:223], v[20:23], v[172:175]
    v_mfma_f32_16x16x32_bf16 v[176:179], v[220:223], v[36:39], v[176:179]
    v_xor_b32 v241, 0, v245
    ds_read_b128 v[216:219], v241 offset:12288
    s_waitcnt lgkmcnt(2)
    v_mfma_f32_16x16x32_bf16 v[168:171], v[224:227], v[8:11], v[168:171]
    v_mfma_f32_16x16x32_bf16 v[172:175], v[224:227], v[24:27], v[172:175]
    v_mfma_f32_16x16x32_bf16 v[176:179], v[224:227], v[40:43], v[176:179]
    v_xor_b32 v241, 64, v245
    ds_read_b128 v[220:223], v241 offset:12288
    s_waitcnt lgkmcnt(2)
    v_mfma_f32_16x16x32_bf16 v[168:171], v[228:231], v[12:15], v[168:171]
    v_mfma_f32_16x16x32_bf16 v[172:175], v[228:231], v[28:31], v[172:175]
    v_mfma_f32_16x16x32_bf16 v[176:179], v[228:231], v[44:47], v[176:179]
    v_xor_b32 v241, 128, v245
    ds_read_b128 v[224:227], v241 offset:12288
    s_waitcnt lgkmcnt(2)
    v_mfma_f32_16x16x32_bf16 v[180:183], v[216:219], v[0:3], v[180:183]
    v_mfma_f32_16x16x32_bf16 v[184:187], v[216:219], v[16:19], v[184:187]
    v_mfma_f32_16x16x32_bf16 v[188:191], v[216:219], v[32:35], v[188:191]
    v_xor_b32 v241, 192, v245
    ds_read_b128 v[228:231], v241 offset:12288
    s_waitcnt lgkmcnt(2)
    v_mfma_f32_16x16x32_bf16 v[180:183], v[220:223], v[4:7], v[180:183]
    v_mfma_f32_16x16x32_bf16 v[184:187], v[220:223], v[20:23], v[184:187]
    v_mfma_f32_16x16x32_bf16 v[188:191], v[220:223], v[36:39], v[188:191]
    s_waitcnt lgkmcnt(1)
    v_mfma_f32_16x16x32_bf16 v[180:183], v[224:227], v[8:11], v[180:183]
    v_mfma_f32_16x16x32_bf16 v[184:187], v[224:227], v[24:27], v[184:187]
    v_mfma_f32_16x16x32_bf16 v[188:191], v[224:227], v[40:43], v[188:191]
    s_waitcnt lgkmcnt(0)
    v_mfma_f32_16x16x32_bf16 v[180:183], v[228:231], v[12:15], v[180:183]
    v_mfma_f32_16x16x32_bf16 v[184:187], v[228:231], v[28:31], v[184:187]
    v_mfma_f32_16x16x32_bf16 v[188:191], v[228:231], v[44:47], v[188:191]
    s_nop 7
    s_nop 1
    v_max3_f32 v241, v144, v145, v146
    v_max_f32 v241, v241, v147
    v_max3_f32 v241, v241, v156, v157
    v_max3_f32 v241, v241, v158, v159
    v_max3_f32 v241, v241, v168, v169
    v_max3_f32 v241, v241, v170, v171
    v_max3_f32 v241, v241, v180, v181
    v_max3_f32 v241, v241, v182, v183
    v_mov_b32 v242, v241
    s_nop 1
    v_permlane32_swap_b32 v241, v242
    v_max_f32 v241, v241, v242
    v_mov_b32 v242, v241
    s_nop 1
    v_permlane16_swap_b32 v241, v242
    v_max3_f32 v241, v241, v242, v232
    v_sub_f32 v242, v232, v241
    v_mul_f32 v242, s43, v242
    v_exp_f32 v238, v242
    v_mov_b32 v232, v241
    v_mul_f32 v241, s43, v241
    v_mul_f32 v235, v235, v238
    v_fma_f32 v144, v144, s43, -v241
    v_exp_f32 v144, v144
    v_fma_f32 v145, v145, s43, -v241
    v_exp_f32 v145, v145
    v_fma_f32 v146, v146, s43, -v241
    v_exp_f32 v146, v146
    v_fma_f32 v147, v147, s43, -v241
    v_exp_f32 v147, v147
    v_fma_f32 v156, v156, s43, -v241
    v_exp_f32 v156, v156
    v_fma_f32 v157, v157, s43, -v241
    v_exp_f32 v157, v157
    v_fma_f32 v158, v158, s43, -v241
    v_exp_f32 v158, v158
    v_fma_f32 v159, v159, s43, -v241
    v_exp_f32 v159, v159
    v_fma_f32 v168, v168, s43, -v241
    v_exp_f32 v168, v168
    v_fma_f32 v169, v169, s43, -v241
    v_exp_f32 v169, v169
    v_fma_f32 v170, v170, s43, -v241
    v_exp_f32 v170, v170
    v_fma_f32 v171, v171, s43, -v241
    v_exp_f32 v171, v171
    v_fma_f32 v180, v180, s43, -v241
    v_exp_f32 v180, v180
    v_fma_f32 v181, v181, s43, -v241
    v_exp_f32 v181, v181
    v_fma_f32 v182, v182, s43, -v241
    v_exp_f32 v182, v182
    v_fma_f32 v183, v183, s43, -v241
    v_exp_f32 v183, v183
    s_nop 0
    v_add_f32 v235, v235, v144
    v_add_f32 v235, v235, v145
    v_add_f32 v235, v235, v146
    v_add_f32 v235, v235, v147
    v_add_f32 v235, v235, v156
    v_add_f32 v235, v235, v157
    v_add_f32 v235, v235, v158
    v_add_f32 v235, v235, v159
    v_add_f32 v235, v235, v168
    v_add_f32 v235, v235, v169
    v_add_f32 v235, v235, v170
    v_add_f32 v235, v235, v171
    v_add_f32 v235, v235, v180
    v_add_f32 v235, v235, v181
    v_add_f32 v235, v235, v182
    v_add_f32 v235, v235, v183
    v_cvt_pk_bf16_f32 v192, v144, v145
    v_cvt_pk_bf16_f32 v193, v146, v147
    v_cvt_pk_bf16_f32 v194, v156, v157
    v_cvt_pk_bf16_f32 v195, v158, v159
    v_cvt_pk_bf16_f32 v204, v168, v169
    v_cvt_pk_bf16_f32 v205, v170, v171
    v_cvt_pk_bf16_f32 v206, v180, v181
    v_cvt_pk_bf16_f32 v207, v182, v183
    v_mul_f32 v48, v48, v238
    v_mul_f32 v49, v49, v238
    v_mul_f32 v50, v50, v238
    v_mul_f32 v51, v51, v238
    v_mul_f32 v60, v60, v238
    v_mul_f32 v61, v61, v238
    v_mul_f32 v62, v62, v238
    v_mul_f32 v63, v63, v238
    v_mul_f32 v72, v72, v238
    v_mul_f32 v73, v73, v238
    v_mul_f32 v74, v74, v238
    v_mul_f32 v75, v75, v238
    v_mul_f32 v84, v84, v238
    v_mul_f32 v85, v85, v238
    v_mul_f32 v86, v86, v238
    v_mul_f32 v87, v87, v238
    v_mul_f32 v96, v96, v238
    v_mul_f32 v97, v97, v238
    v_mul_f32 v98, v98, v238
    v_mul_f32 v99, v99, v238
    v_mul_f32 v108, v108, v238
    v_mul_f32 v109, v109, v238
    v_mul_f32 v110, v110, v238
    v_mul_f32 v111, v111, v238
    v_mul_f32 v120, v120, v238
    v_mul_f32 v121, v121, v238
    v_mul_f32 v122, v122, v238
    v_mul_f32 v123, v123, v238
    v_mul_f32 v132, v132, v238
    v_mul_f32 v133, v133, v238
    v_mul_f32 v134, v134, v238
    v_mul_f32 v135, v135, v238
    v_max3_f32 v241, v148, v149, v150
    v_max_f32 v241, v241, v151
    v_max3_f32 v241, v241, v160, v161
    v_max3_f32 v241, v241, v162, v163
    v_max3_f32 v241, v241, v172, v173
    v_max3_f32 v241, v241, v174, v175
    v_max3_f32 v241, v241, v184, v185
    v_max3_f32 v241, v241, v186, v187
    v_mov_b32 v242, v241
    s_nop 1
    v_permlane32_swap_b32 v241, v242
    v_max_f32 v241, v241, v242
    v_mov_b32 v242, v241
    s_nop 1
    v_permlane16_swap_b32 v241, v242
    v_max3_f32 v241, v241, v242, v233
    v_sub_f32 v242, v233, v241
    v_mul_f32 v242, s43, v242
    v_exp_f32 v239, v242
    v_mov_b32 v233, v241
    v_mul_f32 v241, s43, v241
    v_mul_f32 v236, v236, v239
    v_fma_f32 v148, v148, s43, -v241
    v_exp_f32 v148, v148
    v_fma_f32 v149, v149, s43, -v241
    v_exp_f32 v149, v149
    v_fma_f32 v150, v150, s43, -v241
    v_exp_f32 v150, v150
    v_fma_f32 v151, v151, s43, -v241
    v_exp_f32 v151, v151
    v_fma_f32 v160, v160, s43, -v241
    v_exp_f32 v160, v160
    v_fma_f32 v161, v161, s43, -v241
    v_exp_f32 v161, v161
    v_fma_f32 v162, v162, s43, -v241
    v_exp_f32 v162, v162
    v_fma_f32 v163, v163, s43, -v241
    v_exp_f32 v163, v163
    v_fma_f32 v172, v172, s43, -v241
    v_exp_f32 v172, v172
    v_fma_f32 v173, v173, s43, -v241
    v_exp_f32 v173, v173
    v_fma_f32 v174, v174, s43, -v241
    v_exp_f32 v174, v174
    v_fma_f32 v175, v175, s43, -v241
    v_exp_f32 v175, v175
    v_fma_f32 v184, v184, s43, -v241
    v_exp_f32 v184, v184
    v_fma_f32 v185, v185, s43, -v241
    v_exp_f32 v185, v185
    v_fma_f32 v186, v186, s43, -v241
    v_exp_f32 v186, v186
    v_fma_f32 v187, v187, s43, -v241
    v_exp_f32 v187, v187
    s_nop 0
    v_add_f32 v236, v236, v148
    v_add_f32 v236, v236, v149
    v_add_f32 v236, v236, v150
    v_add_f32 v236, v236, v151
    v_add_f32 v236, v236, v160
    v_add_f32 v236, v236, v161
    v_add_f32 v236, v236, v162
    v_add_f32 v236, v236, v163
    v_add_f32 v236, v236, v172
    v_add_f32 v236, v236, v173
    v_add_f32 v236, v236, v174
    v_add_f32 v236, v236, v175
    v_add_f32 v236, v236, v184
    v_add_f32 v236, v236, v185
    v_add_f32 v236, v236, v186
    v_add_f32 v236, v236, v187
    v_cvt_pk_bf16_f32 v196, v148, v149
    v_cvt_pk_bf16_f32 v197, v150, v151
    v_cvt_pk_bf16_f32 v198, v160, v161
    v_cvt_pk_bf16_f32 v199, v162, v163
    v_cvt_pk_bf16_f32 v208, v172, v173
    v_cvt_pk_bf16_f32 v209, v174, v175
    v_cvt_pk_bf16_f32 v210, v184, v185
    v_cvt_pk_bf16_f32 v211, v186, v187
    v_mul_f32 v52, v52, v239
    v_mul_f32 v53, v53, v239
    v_mul_f32 v54, v54, v239
    v_mul_f32 v55, v55, v239
    v_mul_f32 v64, v64, v239
    v_mul_f32 v65, v65, v239
    v_mul_f32 v66, v66, v239
    v_mul_f32 v67, v67, v239
    v_mul_f32 v76, v76, v239
    v_mul_f32 v77, v77, v239
    v_mul_f32 v78, v78, v239
    v_mul_f32 v79, v79, v239
    v_mul_f32 v88, v88, v239
    v_mul_f32 v89, v89, v239
    v_mul_f32 v90, v90, v239
    v_mul_f32 v91, v91, v239
    v_mul_f32 v100, v100, v239
    v_mul_f32 v101, v101, v239
    v_mul_f32 v102, v102, v239
    v_mul_f32 v103, v103, v239
    v_mul_f32 v112, v112, v239
    v_mul_f32 v113, v113, v239
    v_mul_f32 v114, v114, v239
    v_mul_f32 v115, v115, v239
    v_mul_f32 v124, v124, v239
    v_mul_f32 v125, v125, v239
    v_mul_f32 v126, v126, v239
    v_mul_f32 v127, v127, v239
    v_mul_f32 v136, v136, v239
    v_mul_f32 v137, v137, v239
    v_mul_f32 v138, v138, v239
    v_mul_f32 v139, v139, v239
    v_max3_f32 v241, v152, v153, v154
    v_max_f32 v241, v241, v155
    v_max3_f32 v241, v241, v164, v165
    v_max3_f32 v241, v241, v166, v167
    v_max3_f32 v241, v241, v176, v177
    v_max3_f32 v241, v241, v178, v179
    v_max3_f32 v241, v241, v188, v189
    v_max3_f32 v241, v241, v190, v191
    v_mov_b32 v242, v241
    s_nop 1
    v_permlane32_swap_b32 v241, v242
    v_max_f32 v241, v241, v242
    v_mov_b32 v242, v241
    s_nop 1
    v_permlane16_swap_b32 v241, v242
    v_max3_f32 v241, v241, v242, v234
    v_sub_f32 v242, v234, v241
    v_mul_f32 v242, s43, v242
    v_exp_f32 v240, v242
    v_mov_b32 v234, v241
    v_mul_f32 v241, s43, v241
    v_mul_f32 v237, v237, v240
    v_fma_f32 v152, v152, s43, -v241
    v_exp_f32 v152, v152
    v_fma_f32 v153, v153, s43, -v241
    v_exp_f32 v153, v153
    v_fma_f32 v154, v154, s43, -v241
    v_exp_f32 v154, v154
    v_fma_f32 v155, v155, s43, -v241
    v_exp_f32 v155, v155
    v_fma_f32 v164, v164, s43, -v241
    v_exp_f32 v164, v164
    v_fma_f32 v165, v165, s43, -v241
    v_exp_f32 v165, v165
    v_fma_f32 v166, v166, s43, -v241
    v_exp_f32 v166, v166
    v_fma_f32 v167, v167, s43, -v241
    v_exp_f32 v167, v167
    v_fma_f32 v176, v176, s43, -v241
    v_exp_f32 v176, v176
    v_fma_f32 v177, v177, s43, -v241
    v_exp_f32 v177, v177
    v_fma_f32 v178, v178, s43, -v241
    v_exp_f32 v178, v178
    v_fma_f32 v179, v179, s43, -v241
    v_exp_f32 v179, v179
    v_fma_f32 v188, v188, s43, -v241
    v_exp_f32 v188, v188
    v_fma_f32 v189, v189, s43, -v241
    v_exp_f32 v189, v189
    v_fma_f32 v190, v190, s43, -v241
    v_exp_f32 v190, v190
    v_fma_f32 v191, v191, s43, -v241
    v_exp_f32 v191, v191
    s_nop 0
    v_add_f32 v237, v237, v152
    v_add_f32 v237, v237, v153
    v_add_f32 v237, v237, v154
    v_add_f32 v237, v237, v155
    v_add_f32 v237, v237, v164
    v_add_f32 v237, v237, v165
    v_add_f32 v237, v237, v166
    v_add_f32 v237, v237, v167
    v_add_f32 v237, v237, v176
    v_add_f32 v237, v237, v177
    v_add_f32 v237, v237, v178
    v_add_f32 v237, v237, v179
    v_add_f32 v237, v237, v188
    v_add_f32 v237, v237, v189
    v_add_f32 v237, v237, v190
    v_add_f32 v237, v237, v191
    v_cvt_pk_bf16_f32 v200, v152, v153
    v_cvt_pk_bf16_f32 v201, v154, v155
    v_cvt_pk_bf16_f32 v202, v164, v165
    v_cvt_pk_bf16_f32 v203, v166, v167
    v_cvt_pk_bf16_f32 v212, v176, v177
    v_cvt_pk_bf16_f32 v213, v178, v179
    v_cvt_pk_bf16_f32 v214, v188, v189
    v_cvt_pk_bf16_f32 v215, v190, v191
    v_mul_f32 v56, v56, v240
    v_mul_f32 v57, v57, v240
    v_mul_f32 v58, v58, v240
    v_mul_f32 v59, v59, v240
    v_mul_f32 v68, v68, v240
    v_mul_f32 v69, v69, v240
    v_mul_f32 v70, v70, v240
    v_mul_f32 v71, v71, v240
    v_mul_f32 v80, v80, v240
    v_mul_f32 v81, v81, v240
    v_mul_f32 v82, v82, v240
    v_mul_f32 v83, v83, v240
    v_mul_f32 v92, v92, v240
    v_mul_f32 v93, v93, v240
    v_mul_f32 v94, v94, v240
    v_mul_f32 v95, v95, v240
    v_mul_f32 v104, v104, v240
    v_mul_f32 v105, v105, v240
    v_mul_f32 v106, v106, v240
    v_mul_f32 v107, v107, v240
    v_mul_f32 v116, v116, v240
    v_mul_f32 v117, v117, v240
    v_mul_f32 v118, v118, v240
    v_mul_f32 v119, v119, v240
    v_mul_f32 v128, v128, v240
    v_mul_f32 v129, v129, v240
    v_mul_f32 v130, v130, v240
    v_mul_f32 v131, v131, v240
    v_mul_f32 v140, v140, v240
    v_mul_f32 v141, v141, v240
    v_mul_f32 v142, v142, v240
    v_mul_f32 v143, v143, v240
    s_barrier
    v_xor_b32 v241, 0, v246
    ds_read_b64_tr_b16 v[216:217], v241 offset:16384
    ds_read_b64_tr_b16 v[218:219], v241 offset:20480
    v_xor_b32 v241, 32, v246
    ds_read_b64_tr_b16 v[220:221], v241 offset:16384
    ds_read_b64_tr_b16 v[222:223], v241 offset:20480
    v_xor_b32 v241, 64, v246
    ds_read_b64_tr_b16 v[224:225], v241 offset:16384
    ds_read_b64_tr_b16 v[226:227], v241 offset:20480
    s_waitcnt lgkmcnt(4)
    v_mfma_f32_16x16x32_bf16 v[48:51], v[216:219], v[192:195], v[48:51]
    v_mfma_f32_16x16x32_bf16 v[52:55], v[216:219], v[196:199], v[52:55]
    v_mfma_f32_16x16x32_bf16 v[56:59], v[216:219], v[200:203], v[56:59]
    v_xor_b32 v241, 96, v246
    ds_read_b64_tr_b16 v[228:229], v241 offset:16384
    ds_read_b64_tr_b16 v[230:231], v241 offset:20480
    s_waitcnt lgkmcnt(4)
    v_mfma_f32_16x16x32_bf16 v[60:63], v[220:223], v[192:195], v[60:63]
    v_mfma_f32_16x16x32_bf16 v[64:67], v[220:223], v[196:199], v[64:67]
    v_mfma_f32_16x16x32_bf16 v[68:71], v[220:223], v[200:203], v[68:71]
    v_xor_b32 v241, 128, v246
    ds_read_b64_tr_b16 v[216:217], v241 offset:16384
    ds_read_b64_tr_b16 v[218:219], v241 offset:20480
    s_waitcnt lgkmcnt(4)
    v_mfma_f32_16x16x32_bf16 v[72:75], v[224:227], v[192:195], v[72:75]
    v_mfma_f32_16x16x32_bf16 v[76:79], v[224:227], v[196:199], v[76:79]
    v_mfma_f32_16x16x32_bf16 v[80:83], v[224:227], v[200:203], v[80:83]
    v_xor_b32 v241, 160, v246
    ds_read_b64_tr_b16 v[220:221], v241 offset:16384
    ds_read_b64_tr_b16 v[222:223], v241 offset:20480
    s_waitcnt lgkmcnt(4)
    v_mfma_f32_16x16x32_bf16 v[84:87], v[228:231], v[192:195], v[84:87]
    v_mfma_f32_16x16x32_bf16 v[88:91], v[228:231], v[196:199], v[88:91]
    v_mfma_f32_16x16x32_bf16 v[92:95], v[228:231], v[200:203], v[92:95]
    v_xor_b32 v241, 192, v246
    ds_read_b64_tr_b16 v[224:225], v241 offset:16384
    ds_read_b64_tr_b16 v[226:227], v241 offset:20480
    s_waitcnt lgkmcnt(4)
    v_mfma_f32_16x16x32_bf16 v[96:99], v[216:219], v[192:195], v[96:99]
    v_mfma_f32_16x16x32_bf16 v[100:103], v[216:219], v[196:199], v[100:103]
    v_mfma_f32_16x16x32_bf16 v[104:107], v[216:219], v[200:203], v[104:107]
    v_xor_b32 v241, 224, v246
    ds_read_b64_tr_b16 v[228:229], v241 offset:16384
    ds_read_b64_tr_b16 v[230:231], v241 offset:20480
    s_waitcnt lgkmcnt(4)
    v_mfma_f32_16x16x32_bf16 v[108:111], v[220:223], v[192:195], v[108:111]
    v_mfma_f32_16x16x32_bf16 v[112:115], v[220:223], v[196:199], v[112:115]
    v_mfma_f32_16x16x32_bf16 v[116:119], v[220:223], v[200:203], v[116:119]
    v_xor_b32 v241, 0, v246
    ds_read_b64_tr_b16 v[216:217], v241 offset:24576
    ds_read_b64_tr_b16 v[218:219], v241 offset:28672
    s_waitcnt lgkmcnt(4)
    v_mfma_f32_16x16x32_bf16 v[120:123], v[224:227], v[192:195], v[120:123]
    v_mfma_f32_16x16x32_bf16 v[124:127], v[224:227], v[196:199], v[124:127]
    v_mfma_f32_16x16x32_bf16 v[128:131], v[224:227], v[200:203], v[128:131]
    v_xor_b32 v241, 32, v246
    ds_read_b64_tr_b16 v[220:221], v241 offset:24576
    ds_read_b64_tr_b16 v[222:223], v241 offset:28672
    s_waitcnt lgkmcnt(4)
    v_mfma_f32_16x16x32_bf16 v[132:135], v[228:231], v[192:195], v[132:135]
    v_mfma_f32_16x16x32_bf16 v[136:139], v[228:231], v[196:199], v[136:139]
    v_mfma_f32_16x16x32_bf16 v[140:143], v[228:231], v[200:203], v[140:143]
    v_xor_b32 v241, 64, v246
    ds_read_b64_tr_b16 v[224:225], v241 offset:24576
    ds_read_b64_tr_b16 v[226:227], v241 offset:28672
    s_waitcnt lgkmcnt(4)
    v_mfma_f32_16x16x32_bf16 v[48:51], v[216:219], v[204:207], v[48:51]
    v_mfma_f32_16x16x32_bf16 v[52:55], v[216:219], v[208:211], v[52:55]
    v_mfma_f32_16x16x32_bf16 v[56:59], v[216:219], v[212:215], v[56:59]
    v_xor_b32 v241, 96, v246
    ds_read_b64_tr_b16 v[228:229], v241 offset:24576
    ds_read_b64_tr_b16 v[230:231], v241 offset:28672
    s_waitcnt lgkmcnt(4)
    v_mfma_f32_16x16x32_bf16 v[60:63], v[220:223], v[204:207], v[60:63]
    v_mfma_f32_16x16x32_bf16 v[64:67], v[220:223], v[208:211], v[64:67]
    v_mfma_f32_16x16x32_bf16 v[68:71], v[220:223], v[212:215], v[68:71]
    v_xor_b32 v241, 128, v246
    ds_read_b64_tr_b16 v[216:217], v241 offset:24576
    ds_read_b64_tr_b16 v[218:219], v241 offset:28672
    s_waitcnt lgkmcnt(4)
    v_mfma_f32_16x16x32_bf16 v[72:75], v[224:227], v[204:207], v[72:75]
    v_mfma_f32_16x16x32_bf16 v[76:79], v[224:227], v[208:211], v[76:79]
    v_mfma_f32_16x16x32_bf16 v[80:83], v[224:227], v[212:215], v[80:83]
    v_xor_b32 v241, 160, v246
    ds_read_b64_tr_b16 v[220:221], v241 offset:24576
    ds_read_b64_tr_b16 v[222:223], v241 offset:28672
    s_waitcnt lgkmcnt(4)
    v_mfma_f32_16x16x32_bf16 v[84:87], v[228:231], v[204:207], v[84:87]
    v_mfma_f32_16x16x32_bf16 v[88:91], v[228:231], v[208:211], v[88:91]
    v_mfma_f32_16x16x32_bf16 v[92:95], v[228:231], v[212:215], v[92:95]
    v_xor_b32 v241, 192, v246
    ds_read_b64_tr_b16 v[224:225], v241 offset:24576
    ds_read_b64_tr_b16 v[226:227], v241 offset:28672
    s_waitcnt lgkmcnt(4)
    v_mfma_f32_16x16x32_bf16 v[96:99], v[216:219], v[204:207], v[96:99]
    v_mfma_f32_16x16x32_bf16 v[100:103], v[216:219], v[208:211], v[100:103]
    v_mfma_f32_16x16x32_bf16 v[104:107], v[216:219], v[212:215], v[104:107]
    v_xor_b32 v241, 224, v246
    ds_read_b64_tr_b16 v[228:229], v241 offset:24576
    ds_read_b64_tr_b16 v[230:231], v241 offset:28672
    s_waitcnt lgkmcnt(4)
    v_mfma_f32_16x16x32_bf16 v[108:111], v[220:223], v[204:207], v[108:111]
    v_mfma_f32_16x16x32_bf16 v[112:115], v[220:223], v[208:211], v[112:115]
    v_mfma_f32_16x16x32_bf16 v[116:119], v[220:223], v[212:215], v[116:119]
    s_waitcnt lgkmcnt(2)
    v_mfma_f32_16x16x32_bf16 v[120:123], v[224:227], v[204:207], v[120:123]
    v_mfma_f32_16x16x32_bf16 v[124:127], v[224:227], v[208:211], v[124:127]
    v_mfma_f32_16x16x32_bf16 v[128:131], v[224:227], v[212:215], v[128:131]
    s_waitcnt lgkmcnt(0)
    v_mfma_f32_16x16x32_bf16 v[132:135], v[228:231], v[204:207], v[132:135]
    v_mfma_f32_16x16x32_bf16 v[136:139], v[228:231], v[208:211], v[136:139]
    v_mfma_f32_16x16x32_bf16 v[140:143], v[228:231], v[212:215], v[140:143]
    s_barrier
    v_mov_b32 v144, 0
    v_mov_b32 v145, 0
    v_mov_b32 v146, 0
    v_mov_b32 v147, 0
    v_mov_b32 v148, 0
    v_mov_b32 v149, 0
    v_mov_b32 v150, 0
    v_mov_b32 v151, 0
    v_mov_b32 v152, 0
    v_mov_b32 v153, 0
    v_mov_b32 v154, 0
    v_mov_b32 v155, 0
    v_mov_b32 v156, 0
    v_mov_b32 v157, 0
    v_mov_b32 v158, 0
    v_mov_b32 v159, 0
    v_mov_b32 v160, 0
    v_mov_b32 v161, 0
    v_mov_b32 v162, 0
    v_mov_b32 v163, 0
    v_mov_b32 v164, 0
    v_mov_b32 v165, 0
    v_mov_b32 v166, 0
    v_mov_b32 v167, 0
    v_mov_b32 v168, 0
    v_mov_b32 v169, 0
    v_mov_b32 v170, 0
    v_mov_b32 v171, 0
    v_mov_b32 v172, 0
    v_mov_b32 v173, 0
    v_mov_b32 v174, 0
    v_mov_b32 v175, 0
    v_mov_b32 v176, 0
    v_mov_b32 v177, 0
    v_mov_b32 v178, 0
    v_mov_b32 v179, 0
    v_mov_b32 v180, 0
    v_mov_b32 v181, 0
    v_mov_b32 v182, 0
    v_mov_b32 v183, 0
    v_mov_b32 v184, 0
    v_mov_b32 v185, 0
    v_mov_b32 v186, 0
    v_mov_b32 v187, 0
    v_mov_b32 v188, 0
    v_mov_b32 v189, 0
    v_mov_b32 v190, 0
    v_mov_b32 v191, 0
    v_xor_b32 v241, 0, v245
    ds_read_b128 v[216:219], v241 offset:32768
    v_xor_b32 v241, 64, v245
    ds_read_b128 v[220:223], v241 offset:32768
    v_xor_b32 v241, 128, v245
    ds_read_b128 v[224:227], v241 offset:32768
    s_waitcnt lgkmcnt(2)
    v_mfma_f32_16x16x32_bf16 v[144:147], v[216:219], v[0:3], v[144:147]
    v_mfma_f32_16x16x32_bf16 v[148:151], v[216:219], v[16:19], v[148:151]
    v_mfma_f32_16x16x32_bf16 v[152:155], v[216:219], v[32:35], v[152:155]
    v_xor_b32 v241, 192, v245
    ds_read_b128 v[228:231], v241 offset:32768
    s_waitcnt lgkmcnt(2)
    v_mfma_f32_16x16x32_bf16 v[144:147], v[220:223], v[4:7], v[144:147]
    v_mfma_f32_16x16x32_bf16 v[148:151], v[220:223], v[20:23], v[148:151]
    v_mfma_f32_16x16x32_bf16 v[152:155], v[220:223], v[36:39], v[152:155]
    v_xor_b32 v241, 0, v245
    ds_read_b128 v[216:219], v241 offset:36864
    s_waitcnt lgkmcnt(2)
    v_mfma_f32_16x16x32_bf16 v[144:147], v[224:227], v[8:11], v[144:147]
    v_mfma_f32_16x16x32_bf16 v[148:151], v[224:227], v[24:27], v[148:151]
    v_mfma_f32_16x16x32_bf16 v[152:155], v[224:227], v[40:43], v[152:155]
    v_xor_b32 v241, 64, v245
    ds_read_b128 v[220:223], v241 offset:36864
    s_waitcnt lgkmcnt(2)
    v_mfma_f32_16x16x32_bf16 v[144:147], v[228:231], v[12:15], v[144:147]
    v_mfma_f32_16x16x32_bf16 v[148:151], v[228:231], v[28:31], v[148:151]
    v_mfma_f32_16x16x32_bf16 v[152:155], v[228:231], v[44:47], v[152:155]
    v_xor_b32 v241, 128, v245
    ds_read_b128 v[224:227], v241 offset:36864
    s_waitcnt lgkmcnt(2)
    v_mfma_f32_16x16x32_bf16 v[156:159], v[216:219], v[0:3], v[156:159]
    v_mfma_f32_16x16x32_bf16 v[160:163], v[216:219], v[16:19], v[160:163]
    v_mfma_f32_16x16x32_bf16 v[164:167], v[216:219], v[32:35], v[164:167]
    v_xor_b32 v241, 192, v245
    ds_read_b128 v[228:231], v241 offset:36864
    s_waitcnt lgkmcnt(2)
    v_mfma_f32_16x16x32_bf16 v[156:159], v[220:223], v[4:7], v[156:159]
    v_mfma_f32_16x16x32_bf16 v[160:163], v[220:223], v[20:23], v[160:163]
    v_mfma_f32_16x16x32_bf16 v[164:167], v[220:223], v[36:39], v[164:167]
    v_xor_b32 v241, 0, v245
    ds_read_b128 v[216:219], v241 offset:40960
    s_waitcnt lgkmcnt(2)
    v_mfma_f32_16x16x32_bf16 v[156:159], v[224:227], v[8:11], v[156:159]
    v_mfma_f32_16x16x32_bf16 v[160:163], v[224:227], v[24:27], v[160:163]
    v_mfma_f32_16x16x32_bf16 v[164:167], v[224:227], v[40:43], v[164:167]
    v_xor_b32 v241, 64, v245
    ds_read_b128 v[220:223], v241 offset:40960
    s_waitcnt lgkmcnt(2)
    v_mfma_f32_16x16x32_bf16 v[156:159], v[228:231], v[12:15], v[156:159]
    v_mfma_f32_16x16x32_bf16 v[160:163], v[228:231], v[28:31], v[160:163]
    v_mfma_f32_16x16x32_bf16 v[164:167], v[228:231], v[44:47], v[164:167]
    v_xor_b32 v241, 128, v245
    ds_read_b128 v[224:227], v241 offset:40960
    s_waitcnt lgkmcnt(2)
    v_mfma_f32_16x16x32_bf16 v[168:171], v[216:219], v[0:3], v[168:171]
    v_mfma_f32_16x16x32_bf16 v[172:175], v[216:219], v[16:19], v[172:175]
    v_mfma_f32_16x16x32_bf16 v[176:179], v[216:219], v[32:35], v[176:179]
    v_xor_b32 v241, 192, v245
    ds_read_b128 v[228:231], v241 offset:40960
    s_waitcnt lgkmcnt(2)
    v_mfma_f32_16x16x32_bf16 v[168:171], v[220:223], v[4:7], v[168:171]
    v_mfma_f32_16x16x32_bf16 v[172:175], v[220:223], v[20:23], v[172:175]
    v_mfma_f32_16x16x32_bf16 v[176:179], v[220:223], v[36:39], v[176:179]
    v_xor_b32 v241, 0, v245
    ds_read_b128 v[216:219], v241 offset:45056
    s_waitcnt lgkmcnt(2)
    v_mfma_f32_16x16x32_bf16 v[168:171], v[224:227], v[8:11], v[168:171]
    v_mfma_f32_16x16x32_bf16 v[172:175], v[224:227], v[24:27], v[172:175]
    v_mfma_f32_16x16x32_bf16 v[176:179], v[224:227], v[40:43], v[176:179]
    v_xor_b32 v241, 64, v245
    ds_read_b128 v[220:223], v241 offset:45056
    s_waitcnt lgkmcnt(2)
    v_mfma_f32_16x16x32_bf16 v[168:171], v[228:231], v[12:15], v[168:171]
    v_mfma_f32_16x16x32_bf16 v[172:175], v[228:231], v[28:31], v[172:175]
    v_mfma_f32_16x16x32_bf16 v[176:179], v[228:231], v[44:47], v[176:179]
    v_xor_b32 v241, 128, v245
    ds_read_b128 v[224:227], v241 offset:45056
    s_waitcnt lgkmcnt(2)
    v_mfma_f32_16x16x32_bf16 v[180:183], v[216:219], v[0:3], v[180:183]
    v_mfma_f32_16x16x32_bf16 v[184:187], v[216:219], v[16:19], v[184:187]
    v_mfma_f32_16x16x32_bf16 v[188:191], v[216:219], v[32:35], v[188:191]
    v_xor_b32 v241, 192, v245
    ds_read_b128 v[228:231], v241 offset:45056
    s_waitcnt lgkmcnt(2)
    v_mfma_f32_16x16x32_bf16 v[180:183], v[220:223], v[4:7], v[180:183]
    v_mfma_f32_16x16x32_bf16 v[184:187], v[220:223], v[20:23], v[184:187]
    v_mfma_f32_16x16x32_bf16 v[188:191], v[220:223], v[36:39], v[188:191]
    s_waitcnt lgkmcnt(1)
    v_mfma_f32_16x16x32_bf16 v[180:183], v[224:227], v[8:11], v[180:183]
    v_mfma_f32_16x16x32_bf16 v[184:187], v[224:227], v[24:27], v[184:187]
    v_mfma_f32_16x16x32_bf16 v[188:191], v[224:227], v[40:43], v[188:191]
    s_waitcnt lgkmcnt(0)
    v_mfma_f32_16x16x32_bf16 v[180:183], v[228:231], v[12:15], v[180:183]
    v_mfma_f32_16x16x32_bf16 v[184:187], v[228:231], v[28:31], v[184:187]
    v_mfma_f32_16x16x32_bf16 v[188:191], v[228:231], v[44:47], v[188:191]
    s_nop 7
    s_nop 1
    v_max3_f32 v241, v144, v145, v146
    v_max_f32 v241, v241, v147
    v_max3_f32 v241, v241, v156, v157
    v_max3_f32 v241, v241, v158, v159
    v_max3_f32 v241, v241, v168, v169
    v_max3_f32 v241, v241, v170, v171
    v_max3_f32 v241, v241, v180, v181
    v_max3_f32 v241, v241, v182, v183
    v_mov_b32 v242, v241
    s_nop 1
    v_permlane32_swap_b32 v241, v242
    v_max_f32 v241, v241, v242
    v_mov_b32 v242, v241
    s_nop 1
    v_permlane16_swap_b32 v241, v242
    v_max3_f32 v241, v241, v242, v232
    v_sub_f32 v242, v232, v241
    v_mul_f32 v242, s43, v242
    v_exp_f32 v238, v242
    v_mov_b32 v232, v241
    v_mul_f32 v241, s43, v241
    v_mul_f32 v235, v235, v238
    v_fma_f32 v144, v144, s43, -v241
    v_exp_f32 v144, v144
    v_fma_f32 v145, v145, s43, -v241
    v_exp_f32 v145, v145
    v_fma_f32 v146, v146, s43, -v241
    v_exp_f32 v146, v146
    v_fma_f32 v147, v147, s43, -v241
    v_exp_f32 v147, v147
    v_fma_f32 v156, v156, s43, -v241
    v_exp_f32 v156, v156
    v_fma_f32 v157, v157, s43, -v241
    v_exp_f32 v157, v157
    v_fma_f32 v158, v158, s43, -v241
    v_exp_f32 v158, v158
    v_fma_f32 v159, v159, s43, -v241
    v_exp_f32 v159, v159
    v_fma_f32 v168, v168, s43, -v241
    v_exp_f32 v168, v168
    v_fma_f32 v169, v169, s43, -v241
    v_exp_f32 v169, v169
    v_fma_f32 v170, v170, s43, -v241
    v_exp_f32 v170, v170
    v_fma_f32 v171, v171, s43, -v241
    v_exp_f32 v171, v171
    v_fma_f32 v180, v180, s43, -v241
    v_exp_f32 v180, v180
    v_fma_f32 v181, v181, s43, -v241
    v_exp_f32 v181, v181
    v_fma_f32 v182, v182, s43, -v241
    v_exp_f32 v182, v182
    v_fma_f32 v183, v183, s43, -v241
    v_exp_f32 v183, v183
    s_nop 0
    v_add_f32 v235, v235, v144
    v_add_f32 v235, v235, v145
    v_add_f32 v235, v235, v146
    v_add_f32 v235, v235, v147
    v_add_f32 v235, v235, v156
    v_add_f32 v235, v235, v157
    v_add_f32 v235, v235, v158
    v_add_f32 v235, v235, v159
    v_add_f32 v235, v235, v168
    v_add_f32 v235, v235, v169
    v_add_f32 v235, v235, v170
    v_add_f32 v235, v235, v171
    v_add_f32 v235, v235, v180
    v_add_f32 v235, v235, v181
    v_add_f32 v235, v235, v182
    v_add_f32 v235, v235, v183
    v_cvt_pk_bf16_f32 v192, v144, v145
    v_cvt_pk_bf16_f32 v193, v146, v147
    v_cvt_pk_bf16_f32 v194, v156, v157
    v_cvt_pk_bf16_f32 v195, v158, v159
    v_cvt_pk_bf16_f32 v204, v168, v169
    v_cvt_pk_bf16_f32 v205, v170, v171
    v_cvt_pk_bf16_f32 v206, v180, v181
    v_cvt_pk_bf16_f32 v207, v182, v183
    v_mul_f32 v48, v48, v238
    v_mul_f32 v49, v49, v238
    v_mul_f32 v50, v50, v238
    v_mul_f32 v51, v51, v238
    v_mul_f32 v60, v60, v238
    v_mul_f32 v61, v61, v238
    v_mul_f32 v62, v62, v238
    v_mul_f32 v63, v63, v238
    v_mul_f32 v72, v72, v238
    v_mul_f32 v73, v73, v238
    v_mul_f32 v74, v74, v238
    v_mul_f32 v75, v75, v238
    v_mul_f32 v84, v84, v238
    v_mul_f32 v85, v85, v238
    v_mul_f32 v86, v86, v238
    v_mul_f32 v87, v87, v238
    v_mul_f32 v96, v96, v238
    v_mul_f32 v97, v97, v238
    v_mul_f32 v98, v98, v238
    v_mul_f32 v99, v99, v238
    v_mul_f32 v108, v108, v238
    v_mul_f32 v109, v109, v238
    v_mul_f32 v110, v110, v238
    v_mul_f32 v111, v111, v238
    v_mul_f32 v120, v120, v238
    v_mul_f32 v121, v121, v238
    v_mul_f32 v122, v122, v238
    v_mul_f32 v123, v123, v238
    v_mul_f32 v132, v132, v238
    v_mul_f32 v133, v133, v238
    v_mul_f32 v134, v134, v238
    v_mul_f32 v135, v135, v238
    v_max3_f32 v241, v148, v149, v150
    v_max_f32 v241, v241, v151
    v_max3_f32 v241, v241, v160, v161
    v_max3_f32 v241, v241, v162, v163
    v_max3_f32 v241, v241, v172, v173
    v_max3_f32 v241, v241, v174, v175
    v_max3_f32 v241, v241, v184, v185
    v_max3_f32 v241, v241, v186, v187
    v_mov_b32 v242, v241
    s_nop 1
    v_permlane32_swap_b32 v241, v242
    v_max_f32 v241, v241, v242
    v_mov_b32 v242, v241
    s_nop 1
    v_permlane16_swap_b32 v241, v242
    v_max3_f32 v241, v241, v242, v233
    v_sub_f32 v242, v233, v241
    v_mul_f32 v242, s43, v242
    v_exp_f32 v239, v242
    v_mov_b32 v233, v241
    v_mul_f32 v241, s43, v241
    v_mul_f32 v236, v236, v239
    v_fma_f32 v148, v148, s43, -v241
    v_exp_f32 v148, v148
    v_fma_f32 v149, v149, s43, -v241
    v_exp_f32 v149, v149
    v_fma_f32 v150, v150, s43, -v241
    v_exp_f32 v150, v150
    v_fma_f32 v151, v151, s43, -v241
    v_exp_f32 v151, v151
    v_fma_f32 v160, v160, s43, -v241
    v_exp_f32 v160, v160
    v_fma_f32 v161, v161, s43, -v241
    v_exp_f32 v161, v161
    v_fma_f32 v162, v162, s43, -v241
    v_exp_f32 v162, v162
    v_fma_f32 v163, v163, s43, -v241
    v_exp_f32 v163, v163
    v_fma_f32 v172, v172, s43, -v241
    v_exp_f32 v172, v172
    v_fma_f32 v173, v173, s43, -v241
    v_exp_f32 v173, v173
    v_fma_f32 v174, v174, s43, -v241
    v_exp_f32 v174, v174
    v_fma_f32 v175, v175, s43, -v241
    v_exp_f32 v175, v175
    v_fma_f32 v184, v184, s43, -v241
    v_exp_f32 v184, v184
    v_fma_f32 v185, v185, s43, -v241
    v_exp_f32 v185, v185
    v_fma_f32 v186, v186, s43, -v241
    v_exp_f32 v186, v186
    v_fma_f32 v187, v187, s43, -v241
    v_exp_f32 v187, v187
    s_nop 0
    v_add_f32 v236, v236, v148
    v_add_f32 v236, v236, v149
    v_add_f32 v236, v236, v150
    v_add_f32 v236, v236, v151
    v_add_f32 v236, v236, v160
    v_add_f32 v236, v236, v161
    v_add_f32 v236, v236, v162
    v_add_f32 v236, v236, v163
    v_add_f32 v236, v236, v172
    v_add_f32 v236, v236, v173
    v_add_f32 v236, v236, v174
    v_add_f32 v236, v236, v175
    v_add_f32 v236, v236, v184
    v_add_f32 v236, v236, v185
    v_add_f32 v236, v236, v186
    v_add_f32 v236, v236, v187
    v_cvt_pk_bf16_f32 v196, v148, v149
    v_cvt_pk_bf16_f32 v197, v150, v151
    v_cvt_pk_bf16_f32 v198, v160, v161
    v_cvt_pk_bf16_f32 v199, v162, v163
    v_cvt_pk_bf16_f32 v208, v172, v173
    v_cvt_pk_bf16_f32 v209, v174, v175
    v_cvt_pk_bf16_f32 v210, v184, v185
    v_cvt_pk_bf16_f32 v211, v186, v187
    v_mul_f32 v52, v52, v239
    v_mul_f32 v53, v53, v239
    v_mul_f32 v54, v54, v239
    v_mul_f32 v55, v55, v239
    v_mul_f32 v64, v64, v239
    v_mul_f32 v65, v65, v239
    v_mul_f32 v66, v66, v239
    v_mul_f32 v67, v67, v239
    v_mul_f32 v76, v76, v239
    v_mul_f32 v77, v77, v239
    v_mul_f32 v78, v78, v239
    v_mul_f32 v79, v79, v239
    v_mul_f32 v88, v88, v239
    v_mul_f32 v89, v89, v239
    v_mul_f32 v90, v90, v239
    v_mul_f32 v91, v91, v239
    v_mul_f32 v100, v100, v239
    v_mul_f32 v101, v101, v239
    v_mul_f32 v102, v102, v239
    v_mul_f32 v103, v103, v239
    v_mul_f32 v112, v112, v239
    v_mul_f32 v113, v113, v239
    v_mul_f32 v114, v114, v239
    v_mul_f32 v115, v115, v239
    v_mul_f32 v124, v124, v239
    v_mul_f32 v125, v125, v239
    v_mul_f32 v126, v126, v239
    v_mul_f32 v127, v127, v239
    v_mul_f32 v136, v136, v239
    v_mul_f32 v137, v137, v239
    v_mul_f32 v138, v138, v239
    v_mul_f32 v139, v139, v239
    v_max3_f32 v241, v152, v153, v154
    v_max_f32 v241, v241, v155
    v_max3_f32 v241, v241, v164, v165
    v_max3_f32 v241, v241, v166, v167
    v_max3_f32 v241, v241, v176, v177
    v_max3_f32 v241, v241, v178, v179
    v_max3_f32 v241, v241, v188, v189
    v_max3_f32 v241, v241, v190, v191
    v_mov_b32 v242, v241
    s_nop 1
    v_permlane32_swap_b32 v241, v242
    v_max_f32 v241, v241, v242
    v_mov_b32 v242, v241
    s_nop 1
    v_permlane16_swap_b32 v241, v242
    v_max3_f32 v241, v241, v242, v234
    v_sub_f32 v242, v234, v241
    v_mul_f32 v242, s43, v242
    v_exp_f32 v240, v242
    v_mov_b32 v234, v241
    v_mul_f32 v241, s43, v241
    v_mul_f32 v237, v237, v240
    v_fma_f32 v152, v152, s43, -v241
    v_exp_f32 v152, v152
    v_fma_f32 v153, v153, s43, -v241
    v_exp_f32 v153, v153
    v_fma_f32 v154, v154, s43, -v241
    v_exp_f32 v154, v154
    v_fma_f32 v155, v155, s43, -v241
    v_exp_f32 v155, v155
    v_fma_f32 v164, v164, s43, -v241
    v_exp_f32 v164, v164
    v_fma_f32 v165, v165, s43, -v241
    v_exp_f32 v165, v165
    v_fma_f32 v166, v166, s43, -v241
    v_exp_f32 v166, v166
    v_fma_f32 v167, v167, s43, -v241
    v_exp_f32 v167, v167
    v_fma_f32 v176, v176, s43, -v241
    v_exp_f32 v176, v176
    v_fma_f32 v177, v177, s43, -v241
    v_exp_f32 v177, v177
    v_fma_f32 v178, v178, s43, -v241
    v_exp_f32 v178, v178
    v_fma_f32 v179, v179, s43, -v241
    v_exp_f32 v179, v179
    v_fma_f32 v188, v188, s43, -v241
    v_exp_f32 v188, v188
    v_fma_f32 v189, v189, s43, -v241
    v_exp_f32 v189, v189
    v_fma_f32 v190, v190, s43, -v241
    v_exp_f32 v190, v190
    v_fma_f32 v191, v191, s43, -v241
    v_exp_f32 v191, v191
    s_nop 0
    v_add_f32 v237, v237, v152
    v_add_f32 v237, v237, v153
    v_add_f32 v237, v237, v154
    v_add_f32 v237, v237, v155
    v_add_f32 v237, v237, v164
    v_add_f32 v237, v237, v165
    v_add_f32 v237, v237, v166
    v_add_f32 v237, v237, v167
    v_add_f32 v237, v237, v176
    v_add_f32 v237, v237, v177
    v_add_f32 v237, v237, v178
    v_add_f32 v237, v237, v179
    v_add_f32 v237, v237, v188
    v_add_f32 v237, v237, v189
    v_add_f32 v237, v237, v190
    v_add_f32 v237, v237, v191
    v_cvt_pk_bf16_f32 v200, v152, v153
    v_cvt_pk_bf16_f32 v201, v154, v155
    v_cvt_pk_bf16_f32 v202, v164, v165
    v_cvt_pk_bf16_f32 v203, v166, v167
    v_cvt_pk_bf16_f32 v212, v176, v177
    v_cvt_pk_bf16_f32 v213, v178, v179
    v_cvt_pk_bf16_f32 v214, v188, v189
    v_cvt_pk_bf16_f32 v215, v190, v191
    v_mul_f32 v56, v56, v240
    v_mul_f32 v57, v57, v240
    v_mul_f32 v58, v58, v240
    v_mul_f32 v59, v59, v240
    v_mul_f32 v68, v68, v240
    v_mul_f32 v69, v69, v240
    v_mul_f32 v70, v70, v240
    v_mul_f32 v71, v71, v240
    v_mul_f32 v80, v80, v240
    v_mul_f32 v81, v81, v240
    v_mul_f32 v82, v82, v240
    v_mul_f32 v83, v83, v240
    v_mul_f32 v92, v92, v240
    v_mul_f32 v93, v93, v240
    v_mul_f32 v94, v94, v240
    v_mul_f32 v95, v95, v240
    v_mul_f32 v104, v104, v240
    v_mul_f32 v105, v105, v240
    v_mul_f32 v106, v106, v240
    v_mul_f32 v107, v107, v240
    v_mul_f32 v116, v116, v240
    v_mul_f32 v117, v117, v240
    v_mul_f32 v118, v118, v240
    v_mul_f32 v119, v119, v240
    v_mul_f32 v128, v128, v240
    v_mul_f32 v129, v129, v240
    v_mul_f32 v130, v130, v240
    v_mul_f32 v131, v131, v240
    v_mul_f32 v140, v140, v240
    v_mul_f32 v141, v141, v240
    v_mul_f32 v142, v142, v240
    v_mul_f32 v143, v143, v240
    s_barrier
    v_xor_b32 v241, 0, v246
    ds_read_b64_tr_b16 v[216:217], v241 offset:49152
    ds_read_b64_tr_b16 v[218:219], v241 offset:53248
    v_xor_b32 v241, 32, v246
    ds_read_b64_tr_b16 v[220:221], v241 offset:49152
    ds_read_b64_tr_b16 v[222:223], v241 offset:53248
    v_xor_b32 v241, 64, v246
    ds_read_b64_tr_b16 v[224:225], v241 offset:49152
    ds_read_b64_tr_b16 v[226:227], v241 offset:53248
    s_waitcnt lgkmcnt(4)
    v_mfma_f32_16x16x32_bf16 v[48:51], v[216:219], v[192:195], v[48:51]
    v_mfma_f32_16x16x32_bf16 v[52:55], v[216:219], v[196:199], v[52:55]
    v_mfma_f32_16x16x32_bf16 v[56:59], v[216:219], v[200:203], v[56:59]
    v_xor_b32 v241, 96, v246
    ds_read_b64_tr_b16 v[228:229], v241 offset:49152
    ds_read_b64_tr_b16 v[230:231], v241 offset:53248
    s_waitcnt lgkmcnt(4)
    v_mfma_f32_16x16x32_bf16 v[60:63], v[220:223], v[192:195], v[60:63]
    v_mfma_f32_16x16x32_bf16 v[64:67], v[220:223], v[196:199], v[64:67]
    v_mfma_f32_16x16x32_bf16 v[68:71], v[220:223], v[200:203], v[68:71]
    v_xor_b32 v241, 128, v246
    ds_read_b64_tr_b16 v[216:217], v241 offset:49152
    ds_read_b64_tr_b16 v[218:219], v241 offset:53248
    s_waitcnt lgkmcnt(4)
    v_mfma_f32_16x16x32_bf16 v[72:75], v[224:227], v[192:195], v[72:75]
    v_mfma_f32_16x16x32_bf16 v[76:79], v[224:227], v[196:199], v[76:79]
    v_mfma_f32_16x16x32_bf16 v[80:83], v[224:227], v[200:203], v[80:83]
    v_xor_b32 v241, 160, v246
    ds_read_b64_tr_b16 v[220:221], v241 offset:49152
    ds_read_b64_tr_b16 v[222:223], v241 offset:53248
    s_waitcnt lgkmcnt(4)
    v_mfma_f32_16x16x32_bf16 v[84:87], v[228:231], v[192:195], v[84:87]
    v_mfma_f32_16x16x32_bf16 v[88:91], v[228:231], v[196:199], v[88:91]
    v_mfma_f32_16x16x32_bf16 v[92:95], v[228:231], v[200:203], v[92:95]
    v_xor_b32 v241, 192, v246
    ds_read_b64_tr_b16 v[224:225], v241 offset:49152
    ds_read_b64_tr_b16 v[226:227], v241 offset:53248
    s_waitcnt lgkmcnt(4)
    v_mfma_f32_16x16x32_bf16 v[96:99], v[216:219], v[192:195], v[96:99]
    v_mfma_f32_16x16x32_bf16 v[100:103], v[216:219], v[196:199], v[100:103]
    v_mfma_f32_16x16x32_bf16 v[104:107], v[216:219], v[200:203], v[104:107]
    v_xor_b32 v241, 224, v246
    ds_read_b64_tr_b16 v[228:229], v241 offset:49152
    ds_read_b64_tr_b16 v[230:231], v241 offset:53248
    s_waitcnt lgkmcnt(4)
    v_mfma_f32_16x16x32_bf16 v[108:111], v[220:223], v[192:195], v[108:111]
    v_mfma_f32_16x16x32_bf16 v[112:115], v[220:223], v[196:199], v[112:115]
    v_mfma_f32_16x16x32_bf16 v[116:119], v[220:223], v[200:203], v[116:119]
    v_xor_b32 v241, 0, v246
    ds_read_b64_tr_b16 v[216:217], v241 offset:57344
    ds_read_b64_tr_b16 v[218:219], v241 offset:61440
    s_waitcnt lgkmcnt(4)
    v_mfma_f32_16x16x32_bf16 v[120:123], v[224:227], v[192:195], v[120:123]
    v_mfma_f32_16x16x32_bf16 v[124:127], v[224:227], v[196:199], v[124:127]
    v_mfma_f32_16x16x32_bf16 v[128:131], v[224:227], v[200:203], v[128:131]
    v_xor_b32 v241, 32, v246
    ds_read_b64_tr_b16 v[220:221], v241 offset:57344
    ds_read_b64_tr_b16 v[222:223], v241 offset:61440
    s_waitcnt lgkmcnt(4)
    v_mfma_f32_16x16x32_bf16 v[132:135], v[228:231], v[192:195], v[132:135]
    v_mfma_f32_16x16x32_bf16 v[136:139], v[228:231], v[196:199], v[136:139]
    v_mfma_f32_16x16x32_bf16 v[140:143], v[228:231], v[200:203], v[140:143]
    v_xor_b32 v241, 64, v246
    ds_read_b64_tr_b16 v[224:225], v241 offset:57344
    ds_read_b64_tr_b16 v[226:227], v241 offset:61440
    s_waitcnt lgkmcnt(4)
    v_mfma_f32_16x16x32_bf16 v[48:51], v[216:219], v[204:207], v[48:51]
    v_mfma_f32_16x16x32_bf16 v[52:55], v[216:219], v[208:211], v[52:55]
    v_mfma_f32_16x16x32_bf16 v[56:59], v[216:219], v[212:215], v[56:59]
    v_xor_b32 v241, 96, v246
    ds_read_b64_tr_b16 v[228:229], v241 offset:57344
    ds_read_b64_tr_b16 v[230:231], v241 offset:61440
    s_waitcnt lgkmcnt(4)
    v_mfma_f32_16x16x32_bf16 v[60:63], v[220:223], v[204:207], v[60:63]
    v_mfma_f32_16x16x32_bf16 v[64:67], v[220:223], v[208:211], v[64:67]
    v_mfma_f32_16x16x32_bf16 v[68:71], v[220:223], v[212:215], v[68:71]
    v_xor_b32 v241, 128, v246
    ds_read_b64_tr_b16 v[216:217], v241 offset:57344
    ds_read_b64_tr_b16 v[218:219], v241 offset:61440
    s_waitcnt lgkmcnt(4)
    v_mfma_f32_16x16x32_bf16 v[72:75], v[224:227], v[204:207], v[72:75]
    v_mfma_f32_16x16x32_bf16 v[76:79], v[224:227], v[208:211], v[76:79]
    v_mfma_f32_16x16x32_bf16 v[80:83], v[224:227], v[212:215], v[80:83]
    v_xor_b32 v241, 160, v246
    ds_read_b64_tr_b16 v[220:221], v241 offset:57344
    ds_read_b64_tr_b16 v[222:223], v241 offset:61440
    s_waitcnt lgkmcnt(4)
    v_mfma_f32_16x16x32_bf16 v[84:87], v[228:231], v[204:207], v[84:87]
    v_mfma_f32_16x16x32_bf16 v[88:91], v[228:231], v[208:211], v[88:91]
    v_mfma_f32_16x16x32_bf16 v[92:95], v[228:231], v[212:215], v[92:95]
    v_xor_b32 v241, 192, v246
    ds_read_b64_tr_b16 v[224:225], v241 offset:57344
    ds_read_b64_tr_b16 v[226:227], v241 offset:61440
    s_waitcnt lgkmcnt(4)
    v_mfma_f32_16x16x32_bf16 v[96:99], v[216:219], v[204:207], v[96:99]
    v_mfma_f32_16x16x32_bf16 v[100:103], v[216:219], v[208:211], v[100:103]
    v_mfma_f32_16x16x32_bf16 v[104:107], v[216:219], v[212:215], v[104:107]
    v_xor_b32 v241, 224, v246
    ds_read_b64_tr_b16 v[228:229], v241 offset:57344
    ds_read_b64_tr_b16 v[230:231], v241 offset:61440
    s_waitcnt lgkmcnt(4)
    v_mfma_f32_16x16x32_bf16 v[108:111], v[220:223], v[204:207], v[108:111]
    v_mfma_f32_16x16x32_bf16 v[112:115], v[220:223], v[208:211], v[112:115]
    v_mfma_f32_16x16x32_bf16 v[116:119], v[220:223], v[212:215], v[116:119]
    s_waitcnt lgkmcnt(2)
    v_mfma_f32_16x16x32_bf16 v[120:123], v[224:227], v[204:207], v[120:123]
    v_mfma_f32_16x16x32_bf16 v[124:127], v[224:227], v[208:211], v[124:127]
    v_mfma_f32_16x16x32_bf16 v[128:131], v[224:227], v[212:215], v[128:131]
    s_waitcnt lgkmcnt(0)
    v_mfma_f32_16x16x32_bf16 v[132:135], v[228:231], v[204:207], v[132:135]
    v_mfma_f32_16x16x32_bf16 v[136:139], v[228:231], v[208:211], v[136:139]
    v_mfma_f32_16x16x32_bf16 v[140:143], v[228:231], v[212:215], v[140:143]
    s_sub_u32 s44, s44, 1
    s_cmp_lg_u32 s44, 0
    s_cbranch_scc1 K1_LOOP
    s_nop 7
    s_nop 1
    v_mov_b32 v241, v235
    v_mov_b32 v242, v235
    s_nop 1
    v_permlane32_swap_b32 v241, v242
    v_add_f32 v241, v241, v242
    v_mov_b32 v242, v241
    s_nop 1
    v_permlane16_swap_b32 v241, v242
    v_add_f32 v241, v241, v242
    v_rcp_f32 v241, v241
    s_nop 0
    v_mul_f32 v48, v48, v241
    v_mul_f32 v49, v49, v241
    v_mul_f32 v50, v50, v241
    v_mul_f32 v51, v51, v241
    v_cvt_pk_bf16_f32 v48, v48, v49
    v_cvt_pk_bf16_f32 v49, v50, v51
    s_mov_b32 s45, 0x20000
    s_mov_b32 s46, 0x40000
    buffer_store_dwordx2 v[48:49], v249, s[36:39], s41 offen offset:0
    v_mul_f32 v60, v60, v241
    v_mul_f32 v61, v61, v241
    v_mul_f32 v62, v62, v241
    v_mul_f32 v63, v63, v241
    v_cvt_pk_bf16_f32 v60, v60, v61
    v_cvt_pk_bf16_f32 v61, v62, v63
    buffer_store_dwordx2 v[60:61], v249, s[36:39], s41 offen offset:32
    v_mul_f32 v72, v72, v241
    v_mul_f32 v73, v73, v241
    v_mul_f32 v74, v74, v241
    v_mul_f32 v75, v75, v241
    v_cvt_pk_bf16_f32 v72, v72, v73
    v_cvt_pk_bf16_f32 v73, v74, v75
    buffer_store_dwordx2 v[72:73], v249, s[36:39], s41 offen offset:64
    v_mul_f32 v84, v84, v241
    v_mul_f32 v85, v85, v241
    v_mul_f32 v86, v86, v241
    v_mul_f32 v87, v87, v241
    v_cvt_pk_bf16_f32 v84, v84, v85
    v_cvt_pk_bf16_f32 v85, v86, v87
    buffer_store_dwordx2 v[84:85], v249, s[36:39], s41 offen offset:96
    v_mul_f32 v96, v96, v241
    v_mul_f32 v97, v97, v241
    v_mul_f32 v98, v98, v241
    v_mul_f32 v99, v99, v241
    v_cvt_pk_bf16_f32 v96, v96, v97
    v_cvt_pk_bf16_f32 v97, v98, v99
    buffer_store_dwordx2 v[96:97], v249, s[36:39], s41 offen offset:128
    v_mul_f32 v108, v108, v241
    v_mul_f32 v109, v109, v241
    v_mul_f32 v110, v110, v241
    v_mul_f32 v111, v111, v241
    v_cvt_pk_bf16_f32 v108, v108, v109
    v_cvt_pk_bf16_f32 v109, v110, v111
    buffer_store_dwordx2 v[108:109], v249, s[36:39], s41 offen offset:160
    v_mul_f32 v120, v120, v241
    v_mul_f32 v121, v121, v241
    v_mul_f32 v122, v122, v241
    v_mul_f32 v123, v123, v241
    v_cvt_pk_bf16_f32 v120, v120, v121
    v_cvt_pk_bf16_f32 v121, v122, v123
    buffer_store_dwordx2 v[120:121], v249, s[36:39], s41 offen offset:192
    v_mul_f32 v132, v132, v241
    v_mul_f32 v133, v133, v241
    v_mul_f32 v134, v134, v241
    v_mul_f32 v135, v135, v241
    v_cvt_pk_bf16_f32 v132, v132, v133
    v_cvt_pk_bf16_f32 v133, v134, v135
    buffer_store_dwordx2 v[132:133], v249, s[36:39], s41 offen offset:224
    v_mov_b32 v241, v236
    v_mov_b32 v242, v236
    s_nop 1
    v_permlane32_swap_b32 v241, v242
    v_add_f32 v241, v241, v242
    v_mov_b32 v242, v241
    s_nop 1
    v_permlane16_swap_b32 v241, v242
    v_add_f32 v241, v241, v242
    v_rcp_f32 v241, v241
    s_nop 0
    v_mul_f32 v52, v52, v241
    v_mul_f32 v53, v53, v241
    v_mul_f32 v54, v54, v241
    v_mul_f32 v55, v55, v241
    v_cvt_pk_bf16_f32 v52, v52, v53
    v_cvt_pk_bf16_f32 v53, v54, v55
    buffer_store_dwordx2 v[52:53], v249, s[36:39], s45 offen offset:0
    v_mul_f32 v64, v64, v241
    v_mul_f32 v65, v65, v241
    v_mul_f32 v66, v66, v241
    v_mul_f32 v67, v67, v241
    v_cvt_pk_bf16_f32 v64, v64, v65
    v_cvt_pk_bf16_f32 v65, v66, v67
    buffer_store_dwordx2 v[64:65], v249, s[36:39], s45 offen offset:32
    v_mul_f32 v76, v76, v241
    v_mul_f32 v77, v77, v241
    v_mul_f32 v78, v78, v241
    v_mul_f32 v79, v79, v241
    v_cvt_pk_bf16_f32 v76, v76, v77
    v_cvt_pk_bf16_f32 v77, v78, v79
    buffer_store_dwordx2 v[76:77], v249, s[36:39], s45 offen offset:64
    v_mul_f32 v88, v88, v241
    v_mul_f32 v89, v89, v241
    v_mul_f32 v90, v90, v241
    v_mul_f32 v91, v91, v241
    v_cvt_pk_bf16_f32 v88, v88, v89
    v_cvt_pk_bf16_f32 v89, v90, v91
    buffer_store_dwordx2 v[88:89], v249, s[36:39], s45 offen offset:96
    v_mul_f32 v100, v100, v241
    v_mul_f32 v101, v101, v241
    v_mul_f32 v102, v102, v241
    v_mul_f32 v103, v103, v241
    v_cvt_pk_bf16_f32 v100, v100, v101
    v_cvt_pk_bf16_f32 v101, v102, v103
    buffer_store_dwordx2 v[100:101], v249, s[36:39], s45 offen offset:128
    v_mul_f32 v112, v112, v241
    v_mul_f32 v113, v113, v241
    v_mul_f32 v114, v114, v241
    v_mul_f32 v115, v115, v241
    v_cvt_pk_bf16_f32 v112, v112, v113
    v_cvt_pk_bf16_f32 v113, v114, v115
    buffer_store_dwordx2 v[112:113], v249, s[36:39], s45 offen offset:160
    v_mul_f32 v124, v124, v241
    v_mul_f32 v125, v125, v241
    v_mul_f32 v126, v126, v241
    v_mul_f32 v127, v127, v241
    v_cvt_pk_bf16_f32 v124, v124, v125
    v_cvt_pk_bf16_f32 v125, v126, v127
    buffer_store_dwordx2 v[124:125], v249, s[36:39], s45 offen offset:192
    v_mul_f32 v136, v136, v241
    v_mul_f32 v137, v137, v241
    v_mul_f32 v138, v138, v241
    v_mul_f32 v139, v139, v241
    v_cvt_pk_bf16_f32 v136, v136, v137
    v_cvt_pk_bf16_f32 v137, v138, v139
    buffer_store_dwordx2 v[136:137], v249, s[36:39], s45 offen offset:224
    v_mov_b32 v241, v237
    v_mov_b32 v242, v237
    s_nop 1
    v_permlane32_swap_b32 v241, v242
    v_add_f32 v241, v241, v242
    v_mov_b32 v242, v241
    s_nop 1
    v_permlane16_swap_b32 v241, v242
    v_add_f32 v241, v241, v242
    v_rcp_f32 v241, v241
    s_nop 0
    v_mul_f32 v56, v56, v241
    v_mul_f32 v57, v57, v241
    v_mul_f32 v58, v58, v241
    v_mul_f32 v59, v59, v241
    v_cvt_pk_bf16_f32 v56, v56, v57
    v_cvt_pk_bf16_f32 v57, v58, v59
    buffer_store_dwordx2 v[56:57], v249, s[36:39], s46 offen offset:0
    v_mul_f32 v68, v68, v241
    v_mul_f32 v69, v69, v241
    v_mul_f32 v70, v70, v241
    v_mul_f32 v71, v71, v241
    v_cvt_pk_bf16_f32 v68, v68, v69
    v_cvt_pk_bf16_f32 v69, v70, v71
    buffer_store_dwordx2 v[68:69], v249, s[36:39], s46 offen offset:32
    v_mul_f32 v80, v80, v241
    v_mul_f32 v81, v81, v241
    v_mul_f32 v82, v82, v241
    v_mul_f32 v83, v83, v241
    v_cvt_pk_bf16_f32 v80, v80, v81
    v_cvt_pk_bf16_f32 v81, v82, v83
    buffer_store_dwordx2 v[80:81], v249, s[36:39], s46 offen offset:64
    v_mul_f32 v92, v92, v241
    v_mul_f32 v93, v93, v241
    v_mul_f32 v94, v94, v241
    v_mul_f32 v95, v95, v241
    v_cvt_pk_bf16_f32 v92, v92, v93
    v_cvt_pk_bf16_f32 v93, v94, v95
    buffer_store_dwordx2 v[92:93], v249, s[36:39], s46 offen offset:96
    v_mul_f32 v104, v104, v241
    v_mul_f32 v105, v105, v241
    v_mul_f32 v106, v106, v241
    v_mul_f32 v107, v107, v241
    v_cvt_pk_bf16_f32 v104, v104, v105
    v_cvt_pk_bf16_f32 v105, v106, v107
    buffer_store_dwordx2 v[104:105], v249, s[36:39], s46 offen offset:128
    v_mul_f32 v116, v116, v241
    v_mul_f32 v117, v117, v241
    v_mul_f32 v118, v118, v241
    v_mul_f32 v119, v119, v241
    v_cvt_pk_bf16_f32 v116, v116, v117
    v_cvt_pk_bf16_f32 v117, v118, v119
    buffer_store_dwordx2 v[116:117], v249, s[36:39], s46 offen offset:160
    v_mul_f32 v128, v128, v241
    v_mul_f32 v129, v129, v241
    v_mul_f32 v130, v130, v241
    v_mul_f32 v131, v131, v241
    v_cvt_pk_bf16_f32 v128, v128, v129
    v_cvt_pk_bf16_f32 v129, v130, v131
    buffer_store_dwordx2 v[128:129], v249, s[36:39], s46 offen offset:192
    v_mul_f32 v140, v140, v241
    v_mul_f32 v141, v141, v241
    v_mul_f32 v142, v142, v241
    v_mul_f32 v143, v143, v241
    v_cvt_pk_bf16_f32 v140, v140, v141
    v_cvt_pk_bf16_f32 v141, v142, v143
    buffer_store_dwordx2 v[140:141], v249, s[36:39], s46 offen offset:224
    s_endpgm
K1_LOADER:
    v_and_b32 v1, 15, v0
    v_lshrrev_b32 v2, 4, v0
    v_lshlrev_b32 v3, 2, v2
    v_xor_b32 v3, v3, v1
    v_lshlrev_b32 v3, 4, v3
    v_lshl_add_u32 v3, v2, 13, v3
    s_lshl_b32 s18, s5, 8
    v_add_u32 v10, s18, v3
    v_add_u32 v3, 0, v2
    v_xor_b32 v3, v3, v1
    v_lshlrev_b32 v3, 4, v3
    v_lshl_add_u32 v11, v2, 8, v3
    v_add_u32 v3, 4, v2
    v_xor_b32 v3, v3, v1
    v_lshlrev_b32 v3, 4, v3
    v_lshl_add_u32 v12, v2, 8, v3
    v_add_u32 v3, 8, v2
    v_xor_b32 v3, v3, v1
    v_lshlrev_b32 v3, 4, v3
    v_lshl_add_u32 v13, v2, 8, v3
    v_add_u32 v3, 12, v2
    v_xor_b32 v3, v3, v1
    v_lshlrev_b32 v3, 4, v3
    v_lshl_add_u32 v14, v2, 8, v3
    v_add_u32 v3, 0, v2
    v_lshlrev_b32 v3, 1, v3
    v_xor_b32 v3, v3, v1
    v_lshlrev_b32 v3, 4, v3
    v_lshl_add_u32 v15, v2, 8, v3
    v_add_u32 v3, 4, v2
    v_lshlrev_b32 v3, 1, v3
    v_xor_b32 v3, v3, v1
    v_lshlrev_b32 v3, 4, v3
    v_lshl_add_u32 v16, v2, 8, v3
    s_lshl_b32 s47, s2, 17
    s_mov_b32 m0, 0
    s_mov_b32 s48, 0
    buffer_load_dwordx4 v10, s[32:35], s48 offen lds
    s_mov_b32 m0, 1024
    s_mov_b32 s48, 32768
    buffer_load_dwordx4 v10, s[32:35], s48 offen lds
    s_mov_b32 m0, 2048
    s_mov_b32 s48, 65536
    buffer_load_dwordx4 v10, s[32:35], s48 offen lds
    s_mov_b32 m0, 3072
    s_mov_b32 s48, 98304
    buffer_load_dwordx4 v10, s[32:35], s48 offen lds
    s_mov_b32 m0, 4096
    s_mov_b32 s48, 131072
    buffer_load_dwordx4 v10, s[32:35], s48 offen lds
    s_mov_b32 m0, 5120
    s_mov_b32 s48, 163840
    buffer_load_dwordx4 v10, s[32:35], s48 offen lds
    s_mov_b32 m0, 6144
    s_mov_b32 s48, 196608
    buffer_load_dwordx4 v10, s[32:35], s48 offen lds
    s_mov_b32 m0, 7168
    s_mov_b32 s48, 229376
    buffer_load_dwordx4 v10, s[32:35], s48 offen lds
    s_mov_b32 m0, 8192
    s_mov_b32 s48, 262144
    buffer_load_dwordx4 v10, s[32:35], s48 offen lds
    s_mov_b32 m0, 9216
    s_mov_b32 s48, 294912
    buffer_load_dwordx4 v10, s[32:35], s48 offen lds
    s_mov_b32 m0, 10240
    s_mov_b32 s48, 327680
    buffer_load_dwordx4 v10, s[32:35], s48 offen lds
    s_mov_b32 m0, 11264
    s_mov_b32 s48, 360448
    buffer_load_dwordx4 v10, s[32:35], s48 offen lds
    s_mov_b32 m0, 12288
    s_mov_b32 s48, 393216
    buffer_load_dwordx4 v10, s[32:35], s48 offen lds
    s_mov_b32 m0, 13312
    s_mov_b32 s48, 425984
    buffer_load_dwordx4 v10, s[32:35], s48 offen lds
    s_mov_b32 m0, 14336
    s_mov_b32 s48, 458752
    buffer_load_dwordx4 v10, s[32:35], s48 offen lds
    s_mov_b32 m0, 15360
    s_mov_b32 s48, 491520
    buffer_load_dwordx4 v10, s[32:35], s48 offen lds
    s_mov_b32 m0, 16384
    s_mov_b32 s48, 524288
    buffer_load_dwordx4 v10, s[32:35], s48 offen lds
    s_mov_b32 m0, 17408
    s_mov_b32 s48, 557056
    buffer_load_dwordx4 v10, s[32:35], s48 offen lds
    s_mov_b32 m0, 18432
    s_mov_b32 s48, 589824
    buffer_load_dwordx4 v10, s[32:35], s48 offen lds
    s_mov_b32 m0, 19456
    s_mov_b32 s48, 622592
    buffer_load_dwordx4 v10, s[32:35], s48 offen lds
    s_mov_b32 m0, 20480
    s_mov_b32 s48, 655360
    buffer_load_dwordx4 v10, s[32:35], s48 offen lds
    s_mov_b32 m0, 21504
    s_mov_b32 s48, 688128
    buffer_load_dwordx4 v10, s[32:35], s48 offen lds
    s_mov_b32 m0, 22528
    s_mov_b32 s48, 720896
    buffer_load_dwordx4 v10, s[32:35], s48 offen lds
    s_mov_b32 m0, 23552
    s_mov_b32 s48, 753664
    buffer_load_dwordx4 v10, s[32:35], s48 offen lds
    s_mov_b32 m0, 24576
    s_mov_b32 s48, 786432
    buffer_load_dwordx4 v10, s[32:35], s48 offen lds
    s_mov_b32 m0, 25600
    s_mov_b32 s48, 819200
    buffer_load_dwordx4 v10, s[32:35], s48 offen lds
    s_mov_b32 m0, 26624
    s_mov_b32 s48, 851968
    buffer_load_dwordx4 v10, s[32:35], s48 offen lds
    s_mov_b32 m0, 27648
    s_mov_b32 s48, 884736
    buffer_load_dwordx4 v10, s[32:35], s48 offen lds
    s_mov_b32 m0, 28672
    s_mov_b32 s48, 917504
    buffer_load_dwordx4 v10, s[32:35], s48 offen lds
    s_mov_b32 m0, 29696
    s_mov_b32 s48, 950272
    buffer_load_dwordx4 v10, s[32:35], s48 offen lds
    s_mov_b32 m0, 30720
    s_mov_b32 s48, 983040
    buffer_load_dwordx4 v10, s[32:35], s48 offen lds
    s_mov_b32 m0, 31744
    s_mov_b32 s48, 1015808
    buffer_load_dwordx4 v10, s[32:35], s48 offen lds
    s_mov_b32 m0, 32768
    s_mov_b32 s48, 1048576
    buffer_load_dwordx4 v10, s[32:35], s48 offen lds
    s_mov_b32 m0, 33792
    s_mov_b32 s48, 1081344
    buffer_load_dwordx4 v10, s[32:35], s48 offen lds
    s_mov_b32 m0, 34816
    s_mov_b32 s48, 1114112
    buffer_load_dwordx4 v10, s[32:35], s48 offen lds
    s_mov_b32 m0, 35840
    s_mov_b32 s48, 1146880
    buffer_load_dwordx4 v10, s[32:35], s48 offen lds
    s_mov_b32 m0, 36864
    s_mov_b32 s48, 1179648
    buffer_load_dwordx4 v10, s[32:35], s48 offen lds
    s_mov_b32 m0, 37888
    s_mov_b32 s48, 1212416
    buffer_load_dwordx4 v10, s[32:35], s48 offen lds
    s_mov_b32 m0, 38912
    s_mov_b32 s48, 1245184
    buffer_load_dwordx4 v10, s[32:35], s48 offen lds
    s_mov_b32 m0, 39936
    s_mov_b32 s48, 1277952
    buffer_load_dwordx4 v10, s[32:35], s48 offen lds
    s_mov_b32 m0, 40960
    s_mov_b32 s48, 1310720
    buffer_load_dwordx4 v10, s[32:35], s48 offen lds
    s_mov_b32 m0, 41984
    s_mov_b32 s48, 1343488
    buffer_load_dwordx4 v10, s[32:35], s48 offen lds
    s_mov_b32 m0, 43008
    s_mov_b32 s48, 1376256
    buffer_load_dwordx4 v10, s[32:35], s48 offen lds
    s_mov_b32 m0, 44032
    s_mov_b32 s48, 1409024
    buffer_load_dwordx4 v10, s[32:35], s48 offen lds
    s_mov_b32 m0, 45056
    s_mov_b32 s48, 1441792
    buffer_load_dwordx4 v10, s[32:35], s48 offen lds
    s_mov_b32 m0, 46080
    s_mov_b32 s48, 1474560
    buffer_load_dwordx4 v10, s[32:35], s48 offen lds
    s_mov_b32 m0, 47104
    s_mov_b32 s48, 1507328
    buffer_load_dwordx4 v10, s[32:35], s48 offen lds
    s_mov_b32 m0, 48128
    s_mov_b32 s48, 1540096
    buffer_load_dwordx4 v10, s[32:35], s48 offen lds
    s_waitcnt vmcnt(32)
    s_barrier
    s_mov_b32 m0, 49152
    s_mov_b32 s48, 1572864
    buffer_load_dwordx4 v10, s[32:35], s48 offen lds
    s_mov_b32 m0, 50176
    s_mov_b32 s48, 1605632
    buffer_load_dwordx4 v10, s[32:35], s48 offen lds
    s_mov_b32 m0, 51200
    s_mov_b32 s48, 1638400
    buffer_load_dwordx4 v10, s[32:35], s48 offen lds
    s_mov_b32 m0, 52224
    s_mov_b32 s48, 1671168
    buffer_load_dwordx4 v10, s[32:35], s48 offen lds
    s_mov_b32 m0, 53248
    s_mov_b32 s48, 1703936
    buffer_load_dwordx4 v10, s[32:35], s48 offen lds
    s_mov_b32 m0, 54272
    s_mov_b32 s48, 1736704
    buffer_load_dwordx4 v10, s[32:35], s48 offen lds
    s_mov_b32 m0, 55296
    s_mov_b32 s48, 1769472
    buffer_load_dwordx4 v10, s[32:35], s48 offen lds
    s_mov_b32 m0, 56320
    s_mov_b32 s48, 1802240
    buffer_load_dwordx4 v10, s[32:35], s48 offen lds
    s_mov_b32 m0, 57344
    s_mov_b32 s48, 1835008
    buffer_load_dwordx4 v10, s[32:35], s48 offen lds
    s_mov_b32 m0, 58368
    s_mov_b32 s48, 1867776
    buffer_load_dwordx4 v10, s[32:35], s48 offen lds
    s_mov_b32 m0, 59392
    s_mov_b32 s48, 1900544
    buffer_load_dwordx4 v10, s[32:35], s48 offen lds
    s_mov_b32 m0, 60416
    s_mov_b32 s48, 1933312
    buffer_load_dwordx4 v10, s[32:35], s48 offen lds
    s_mov_b32 m0, 61440
    s_mov_b32 s48, 1966080
    buffer_load_dwordx4 v10, s[32:35], s48 offen lds
    s_mov_b32 m0, 62464
    s_mov_b32 s48, 1998848
    buffer_load_dwordx4 v10, s[32:35], s48 offen lds
    s_mov_b32 m0, 63488
    s_mov_b32 s48, 2031616
    buffer_load_dwordx4 v10, s[32:35], s48 offen lds
    s_mov_b32 m0, 64512
    s_mov_b32 s48, 2064384
    buffer_load_dwordx4 v10, s[32:35], s48 offen lds
    s_waitcnt vmcnt(32)
    s_barrier
    s_mov_b32 m0, 0
    s_mov_b32 s48, 2097152
    buffer_load_dwordx4 v10, s[32:35], s48 offen lds
    s_mov_b32 m0, 1024
    s_mov_b32 s48, 2129920
    buffer_load_dwordx4 v10, s[32:35], s48 offen lds
    s_mov_b32 m0, 2048
    s_mov_b32 s48, 2162688
    buffer_load_dwordx4 v10, s[32:35], s48 offen lds
    s_mov_b32 m0, 3072
    s_mov_b32 s48, 2195456
    buffer_load_dwordx4 v10, s[32:35], s48 offen lds
    s_mov_b32 m0, 4096
    s_mov_b32 s48, 2228224
    buffer_load_dwordx4 v10, s[32:35], s48 offen lds
    s_mov_b32 m0, 5120
    s_mov_b32 s48, 2260992
    buffer_load_dwordx4 v10, s[32:35], s48 offen lds
    s_mov_b32 m0, 6144
    s_mov_b32 s48, 2293760
    buffer_load_dwordx4 v10, s[32:35], s48 offen lds
    s_mov_b32 m0, 7168
    s_mov_b32 s48, 2326528
    buffer_load_dwordx4 v10, s[32:35], s48 offen lds
    s_mov_b32 m0, 8192
    s_mov_b32 s48, 2359296
    buffer_load_dwordx4 v10, s[32:35], s48 offen lds
    s_mov_b32 m0, 9216
    s_mov_b32 s48, 2392064
    buffer_load_dwordx4 v10, s[32:35], s48 offen lds
    s_mov_b32 m0, 10240
    s_mov_b32 s48, 2424832
    buffer_load_dwordx4 v10, s[32:35], s48 offen lds
    s_mov_b32 m0, 11264
    s_mov_b32 s48, 2457600
    buffer_load_dwordx4 v10, s[32:35], s48 offen lds
    s_mov_b32 m0, 12288
    s_mov_b32 s48, 2490368
    buffer_load_dwordx4 v10, s[32:35], s48 offen lds
    s_mov_b32 m0, 13312
    s_mov_b32 s48, 2523136
    buffer_load_dwordx4 v10, s[32:35], s48 offen lds
    s_mov_b32 m0, 14336
    s_mov_b32 s48, 2555904
    buffer_load_dwordx4 v10, s[32:35], s48 offen lds
    s_mov_b32 m0, 15360
    s_mov_b32 s48, 2588672
    buffer_load_dwordx4 v10, s[32:35], s48 offen lds
    s_waitcnt vmcnt(32)
    s_barrier
    s_mov_b32 m0, 16384
    s_mov_b32 s48, 2621440
    buffer_load_dwordx4 v10, s[32:35], s48 offen lds
    s_mov_b32 m0, 17408
    s_mov_b32 s48, 2654208
    buffer_load_dwordx4 v10, s[32:35], s48 offen lds
    s_mov_b32 m0, 18432
    s_mov_b32 s48, 2686976
    buffer_load_dwordx4 v10, s[32:35], s48 offen lds
    s_mov_b32 m0, 19456
    s_mov_b32 s48, 2719744
    buffer_load_dwordx4 v10, s[32:35], s48 offen lds
    s_mov_b32 m0, 20480
    s_mov_b32 s48, 2752512
    buffer_load_dwordx4 v10, s[32:35], s48 offen lds
    s_mov_b32 m0, 21504
    s_mov_b32 s48, 2785280
    buffer_load_dwordx4 v10, s[32:35], s48 offen lds
    s_mov_b32 m0, 22528
    s_mov_b32 s48, 2818048
    buffer_load_dwordx4 v10, s[32:35], s48 offen lds
    s_mov_b32 m0, 23552
    s_mov_b32 s48, 2850816
    buffer_load_dwordx4 v10, s[32:35], s48 offen lds
    s_mov_b32 m0, 24576
    s_mov_b32 s48, 2883584
    buffer_load_dwordx4 v10, s[32:35], s48 offen lds
    s_mov_b32 m0, 25600
    s_mov_b32 s48, 2916352
    buffer_load_dwordx4 v10, s[32:35], s48 offen lds
    s_mov_b32 m0, 26624
    s_mov_b32 s48, 2949120
    buffer_load_dwordx4 v10, s[32:35], s48 offen lds
    s_mov_b32 m0, 27648
    s_mov_b32 s48, 2981888
    buffer_load_dwordx4 v10, s[32:35], s48 offen lds
    s_mov_b32 m0, 28672
    s_mov_b32 s48, 3014656
    buffer_load_dwordx4 v10, s[32:35], s48 offen lds
    s_mov_b32 m0, 29696
    s_mov_b32 s48, 3047424
    buffer_load_dwordx4 v10, s[32:35], s48 offen lds
    s_mov_b32 m0, 30720
    s_mov_b32 s48, 3080192
    buffer_load_dwordx4 v10, s[32:35], s48 offen lds
    s_mov_b32 m0, 31744
    s_mov_b32 s48, 3112960
    buffer_load_dwordx4 v10, s[32:35], s48 offen lds
    s_waitcnt vmcnt(32)
    s_barrier
    s_mov_b32 m0, 32768
    s_mov_b32 s48, 3145728
    buffer_load_dwordx4 v10, s[32:35], s48 offen lds
    s_mov_b32 m0, 33792
    s_mov_b32 s48, 3178496
    buffer_load_dwordx4 v10, s[32:35], s48 offen lds
    s_mov_b32 m0, 34816
    s_mov_b32 s48, 3211264
    buffer_load_dwordx4 v10, s[32:35], s48 offen lds
    s_mov_b32 m0, 35840
    s_mov_b32 s48, 3244032
    buffer_load_dwordx4 v10, s[32:35], s48 offen lds
    s_mov_b32 m0, 36864
    s_mov_b32 s48, 3276800
    buffer_load_dwordx4 v10, s[32:35], s48 offen lds
    s_mov_b32 m0, 37888
    s_mov_b32 s48, 3309568
    buffer_load_dwordx4 v10, s[32:35], s48 offen lds
    s_mov_b32 m0, 38912
    s_mov_b32 s48, 3342336
    buffer_load_dwordx4 v10, s[32:35], s48 offen lds
    s_mov_b32 m0, 39936
    s_mov_b32 s48, 3375104
    buffer_load_dwordx4 v10, s[32:35], s48 offen lds
    s_mov_b32 m0, 40960
    s_mov_b32 s48, 3407872
    buffer_load_dwordx4 v10, s[32:35], s48 offen lds
    s_mov_b32 m0, 41984
    s_mov_b32 s48, 3440640
    buffer_load_dwordx4 v10, s[32:35], s48 offen lds
    s_mov_b32 m0, 43008
    s_mov_b32 s48, 3473408
    buffer_load_dwordx4 v10, s[32:35], s48 offen lds
    s_mov_b32 m0, 44032
    s_mov_b32 s48, 3506176
    buffer_load_dwordx4 v10, s[32:35], s48 offen lds
    s_mov_b32 m0, 45056
    s_mov_b32 s48, 3538944
    buffer_load_dwordx4 v10, s[32:35], s48 offen lds
    s_mov_b32 m0, 46080
    s_mov_b32 s48, 3571712
    buffer_load_dwordx4 v10, s[32:35], s48 offen lds
    s_mov_b32 m0, 47104
    s_mov_b32 s48, 3604480
    buffer_load_dwordx4 v10, s[32:35], s48 offen lds
    s_mov_b32 m0, 48128
    s_mov_b32 s48, 3637248
    buffer_load_dwordx4 v10, s[32:35], s48 offen lds
    s_waitcnt vmcnt(32)
    s_barrier
    s_mov_b32 m0, 49152
    s_mov_b32 s48, 3670016
    buffer_load_dwordx4 v10, s[32:35], s48 offen lds
    s_mov_b32 m0, 50176
    s_mov_b32 s48, 3702784
    buffer_load_dwordx4 v10, s[32:35], s48 offen lds
    s_mov_b32 m0, 51200
    s_mov_b32 s48, 3735552
    buffer_load_dwordx4 v10, s[32:35], s48 offen lds
    s_mov_b32 m0, 52224
    s_mov_b32 s48, 3768320
    buffer_load_dwordx4 v10, s[32:35], s48 offen lds
    s_mov_b32 m0, 53248
    s_mov_b32 s48, 3801088
    buffer_load_dwordx4 v10, s[32:35], s48 offen lds
    s_mov_b32 m0, 54272
    s_mov_b32 s48, 3833856
    buffer_load_dwordx4 v10, s[32:35], s48 offen lds
    s_mov_b32 m0, 55296
    s_mov_b32 s48, 3866624
    buffer_load_dwordx4 v10, s[32:35], s48 offen lds
    s_mov_b32 m0, 56320
    s_mov_b32 s48, 3899392
    buffer_load_dwordx4 v10, s[32:35], s48 offen lds
    s_mov_b32 m0, 57344
    s_mov_b32 s48, 3932160
    buffer_load_dwordx4 v10, s[32:35], s48 offen lds
    s_mov_b32 m0, 58368
    s_mov_b32 s48, 3964928
    buffer_load_dwordx4 v10, s[32:35], s48 offen lds
    s_mov_b32 m0, 59392
    s_mov_b32 s48, 3997696
    buffer_load_dwordx4 v10, s[32:35], s48 offen lds
    s_mov_b32 m0, 60416
    s_mov_b32 s48, 4030464
    buffer_load_dwordx4 v10, s[32:35], s48 offen lds
    s_mov_b32 m0, 61440
    s_mov_b32 s48, 4063232
    buffer_load_dwordx4 v10, s[32:35], s48 offen lds
    s_mov_b32 m0, 62464
    s_mov_b32 s48, 4096000
    buffer_load_dwordx4 v10, s[32:35], s48 offen lds
    s_mov_b32 m0, 63488
    s_mov_b32 s48, 4128768
    buffer_load_dwordx4 v10, s[32:35], s48 offen lds
    s_mov_b32 m0, 64512
    s_mov_b32 s48, 4161536
    buffer_load_dwordx4 v10, s[32:35], s48 offen lds
    s_waitcnt vmcnt(32)
    s_barrier
    s_mov_b32 m0, 0
    s_add_u32 s48, s47, 0
    buffer_load_dwordx4 v11, s[24:27], s48 offen lds
    s_mov_b32 m0, 1024
    s_add_u32 s48, s47, 1024
    buffer_load_dwordx4 v12, s[24:27], s48 offen lds
    s_mov_b32 m0, 2048
    s_add_u32 s48, s47, 2048
    buffer_load_dwordx4 v13, s[24:27], s48 offen lds
    s_mov_b32 m0, 3072
    s_add_u32 s48, s47, 3072
    buffer_load_dwordx4 v14, s[24:27], s48 offen lds
    s_mov_b32 m0, 4096
    s_add_u32 s48, s47, 4096
    buffer_load_dwordx4 v11, s[24:27], s48 offen lds
    s_mov_b32 m0, 5120
    s_add_u32 s48, s47, 5120
    buffer_load_dwordx4 v12, s[24:27], s48 offen lds
    s_mov_b32 m0, 6144
    s_add_u32 s48, s47, 6144
    buffer_load_dwordx4 v13, s[24:27], s48 offen lds
    s_mov_b32 m0, 7168
    s_add_u32 s48, s47, 7168
    buffer_load_dwordx4 v14, s[24:27], s48 offen lds
    s_mov_b32 m0, 8192
    s_add_u32 s48, s47, 8192
    buffer_load_dwordx4 v11, s[24:27], s48 offen lds
    s_mov_b32 m0, 9216
    s_add_u32 s48, s47, 9216
    buffer_load_dwordx4 v12, s[24:27], s48 offen lds
    s_mov_b32 m0, 10240
    s_add_u32 s48, s47, 10240
    buffer_load_dwordx4 v13, s[24:27], s48 offen lds
    s_mov_b32 m0, 11264
    s_add_u32 s48, s47, 11264
    buffer_load_dwordx4 v14, s[24:27], s48 offen lds
    s_mov_b32 m0, 12288
    s_add_u32 s48, s47, 12288
    buffer_load_dwordx4 v11, s[24:27], s48 offen lds
    s_mov_b32 m0, 13312
    s_add_u32 s48, s47, 13312
    buffer_load_dwordx4 v12, s[24:27], s48 offen lds
    s_mov_b32 m0, 14336
    s_add_u32 s48, s47, 14336
    buffer_load_dwordx4 v13, s[24:27], s48 offen lds
    s_mov_b32 m0, 15360
    s_add_u32 s48, s47, 15360
    buffer_load_dwordx4 v14, s[24:27], s48 offen lds
    s_waitcnt vmcnt(32)
    s_barrier
    s_mov_b32 m0, 16384
    s_add_u32 s48, s47, 0
    buffer_load_dwordx4 v15, s[28:31], s48 offen lds
    s_mov_b32 m0, 17408
    s_add_u32 s48, s47, 1024
    buffer_load_dwordx4 v16, s[28:31], s48 offen lds
    s_mov_b32 m0, 18432
    s_add_u32 s48, s47, 2048
    buffer_load_dwordx4 v15, s[28:31], s48 offen lds
    s_mov_b32 m0, 19456
    s_add_u32 s48, s47, 3072
    buffer_load_dwordx4 v16, s[28:31], s48 offen lds
    s_mov_b32 m0, 20480
    s_add_u32 s48, s47, 4096
    buffer_load_dwordx4 v15, s[28:31], s48 offen lds
    s_mov_b32 m0, 21504
    s_add_u32 s48, s47, 5120
    buffer_load_dwordx4 v16, s[28:31], s48 offen lds
    s_mov_b32 m0, 22528
    s_add_u32 s48, s47, 6144
    buffer_load_dwordx4 v15, s[28:31], s48 offen lds
    s_mov_b32 m0, 23552
    s_add_u32 s48, s47, 7168
    buffer_load_dwordx4 v16, s[28:31], s48 offen lds
    s_mov_b32 m0, 24576
    s_add_u32 s48, s47, 8192
    buffer_load_dwordx4 v15, s[28:31], s48 offen lds
    s_mov_b32 m0, 25600
    s_add_u32 s48, s47, 9216
    buffer_load_dwordx4 v16, s[28:31], s48 offen lds
    s_mov_b32 m0, 26624
    s_add_u32 s48, s47, 10240
    buffer_load_dwordx4 v15, s[28:31], s48 offen lds
    s_mov_b32 m0, 27648
    s_add_u32 s48, s47, 11264
    buffer_load_dwordx4 v16, s[28:31], s48 offen lds
    s_mov_b32 m0, 28672
    s_add_u32 s48, s47, 12288
    buffer_load_dwordx4 v15, s[28:31], s48 offen lds
    s_mov_b32 m0, 29696
    s_add_u32 s48, s47, 13312
    buffer_load_dwordx4 v16, s[28:31], s48 offen lds
    s_mov_b32 m0, 30720
    s_add_u32 s48, s47, 14336
    buffer_load_dwordx4 v15, s[28:31], s48 offen lds
    s_mov_b32 m0, 31744
    s_add_u32 s48, s47, 15360
    buffer_load_dwordx4 v16, s[28:31], s48 offen lds
    s_waitcnt vmcnt(32)
    s_barrier
    s_mov_b32 m0, 32768
    s_add_u32 s48, s47, 16384
    buffer_load_dwordx4 v11, s[24:27], s48 offen lds
    s_mov_b32 m0, 33792
    s_add_u32 s48, s47, 17408
    buffer_load_dwordx4 v12, s[24:27], s48 offen lds
    s_mov_b32 m0, 34816
    s_add_u32 s48, s47, 18432
    buffer_load_dwordx4 v13, s[24:27], s48 offen lds
    s_mov_b32 m0, 35840
    s_add_u32 s48, s47, 19456
    buffer_load_dwordx4 v14, s[24:27], s48 offen lds
    s_mov_b32 m0, 36864
    s_add_u32 s48, s47, 20480
    buffer_load_dwordx4 v11, s[24:27], s48 offen lds
    s_mov_b32 m0, 37888
    s_add_u32 s48, s47, 21504
    buffer_load_dwordx4 v12, s[24:27], s48 offen lds
    s_mov_b32 m0, 38912
    s_add_u32 s48, s47, 22528
    buffer_load_dwordx4 v13, s[24:27], s48 offen lds
    s_mov_b32 m0, 39936
    s_add_u32 s48, s47, 23552
    buffer_load_dwordx4 v14, s[24:27], s48 offen lds
    s_mov_b32 m0, 40960
    s_add_u32 s48, s47, 24576
    buffer_load_dwordx4 v11, s[24:27], s48 offen lds
    s_mov_b32 m0, 41984
    s_add_u32 s48, s47, 25600
    buffer_load_dwordx4 v12, s[24:27], s48 offen lds
    s_mov_b32 m0, 43008
    s_add_u32 s48, s47, 26624
    buffer_load_dwordx4 v13, s[24:27], s48 offen lds
    s_mov_b32 m0, 44032
    s_add_u32 s48, s47, 27648
    buffer_load_dwordx4 v14, s[24:27], s48 offen lds
    s_mov_b32 m0, 45056
    s_add_u32 s48, s47, 28672
    buffer_load_dwordx4 v11, s[24:27], s48 offen lds
    s_mov_b32 m0, 46080
    s_add_u32 s48, s47, 29696
    buffer_load_dwordx4 v12, s[24:27], s48 offen lds
    s_mov_b32 m0, 47104
    s_add_u32 s48, s47, 30720
    buffer_load_dwordx4 v13, s[24:27], s48 offen lds
    s_mov_b32 m0, 48128
    s_add_u32 s48, s47, 31744
    buffer_load_dwordx4 v14, s[24:27], s48 offen lds
    s_waitcnt vmcnt(32)
    s_barrier
    s_mov_b32 m0, 49152
    s_add_u32 s48, s47, 16384
    buffer_load_dwordx4 v15, s[28:31], s48 offen lds
    s_mov_b32 m0, 50176
    s_add_u32 s48, s47, 17408
    buffer_load_dwordx4 v16, s[28:31], s48 offen lds
    s_mov_b32 m0, 51200
    s_add_u32 s48, s47, 18432
    buffer_load_dwordx4 v15, s[28:31], s48 offen lds
    s_mov_b32 m0, 52224
    s_add_u32 s48, s47, 19456
    buffer_load_dwordx4 v16, s[28:31], s48 offen lds
    s_mov_b32 m0, 53248
    s_add_u32 s48, s47, 20480
    buffer_load_dwordx4 v15, s[28:31], s48 offen lds
    s_mov_b32 m0, 54272
    s_add_u32 s48, s47, 21504
    buffer_load_dwordx4 v16, s[28:31], s48 offen lds
    s_mov_b32 m0, 55296
    s_add_u32 s48, s47, 22528
    buffer_load_dwordx4 v15, s[28:31], s48 offen lds
    s_mov_b32 m0, 56320
    s_add_u32 s48, s47, 23552
    buffer_load_dwordx4 v16, s[28:31], s48 offen lds
    s_mov_b32 m0, 57344
    s_add_u32 s48, s47, 24576
    buffer_load_dwordx4 v15, s[28:31], s48 offen lds
    s_mov_b32 m0, 58368
    s_add_u32 s48, s47, 25600
    buffer_load_dwordx4 v16, s[28:31], s48 offen lds
    s_mov_b32 m0, 59392
    s_add_u32 s48, s47, 26624
    buffer_load_dwordx4 v15, s[28:31], s48 offen lds
    s_mov_b32 m0, 60416
    s_add_u32 s48, s47, 27648
    buffer_load_dwordx4 v16, s[28:31], s48 offen lds
    s_mov_b32 m0, 61440
    s_add_u32 s48, s47, 28672
    buffer_load_dwordx4 v15, s[28:31], s48 offen lds
    s_mov_b32 m0, 62464
    s_add_u32 s48, s47, 29696
    buffer_load_dwordx4 v16, s[28:31], s48 offen lds
    s_mov_b32 m0, 63488
    s_add_u32 s48, s47, 30720
    buffer_load_dwordx4 v15, s[28:31], s48 offen lds
    s_mov_b32 m0, 64512
    s_add_u32 s48, s47, 31744
    buffer_load_dwordx4 v16, s[28:31], s48 offen lds
    s_waitcnt vmcnt(32)
    s_barrier
    s_mov_b32 m0, 0
    s_add_u32 s48, s47, 32768
    buffer_load_dwordx4 v11, s[24:27], s48 offen lds
    s_mov_b32 m0, 1024
    s_add_u32 s48, s47, 33792
    buffer_load_dwordx4 v12, s[24:27], s48 offen lds
    s_mov_b32 m0, 2048
    s_add_u32 s48, s47, 34816
    buffer_load_dwordx4 v13, s[24:27], s48 offen lds
    s_mov_b32 m0, 3072
    s_add_u32 s48, s47, 35840
    buffer_load_dwordx4 v14, s[24:27], s48 offen lds
    s_mov_b32 m0, 4096
    s_add_u32 s48, s47, 36864
    buffer_load_dwordx4 v11, s[24:27], s48 offen lds
    s_mov_b32 m0, 5120
    s_add_u32 s48, s47, 37888
    buffer_load_dwordx4 v12, s[24:27], s48 offen lds
    s_mov_b32 m0, 6144
    s_add_u32 s48, s47, 38912
    buffer_load_dwordx4 v13, s[24:27], s48 offen lds
    s_mov_b32 m0, 7168
    s_add_u32 s48, s47, 39936
    buffer_load_dwordx4 v14, s[24:27], s48 offen lds
    s_mov_b32 m0, 8192
    s_add_u32 s48, s47, 40960
    buffer_load_dwordx4 v11, s[24:27], s48 offen lds
    s_mov_b32 m0, 9216
    s_add_u32 s48, s47, 41984
    buffer_load_dwordx4 v12, s[24:27], s48 offen lds
    s_mov_b32 m0, 10240
    s_add_u32 s48, s47, 43008
    buffer_load_dwordx4 v13, s[24:27], s48 offen lds
    s_mov_b32 m0, 11264
    s_add_u32 s48, s47, 44032
    buffer_load_dwordx4 v14, s[24:27], s48 offen lds
    s_mov_b32 m0, 12288
    s_add_u32 s48, s47, 45056
    buffer_load_dwordx4 v11, s[24:27], s48 offen lds
    s_mov_b32 m0, 13312
    s_add_u32 s48, s47, 46080
    buffer_load_dwordx4 v12, s[24:27], s48 offen lds
    s_mov_b32 m0, 14336
    s_add_u32 s48, s47, 47104
    buffer_load_dwordx4 v13, s[24:27], s48 offen lds
    s_mov_b32 m0, 15360
    s_add_u32 s48, s47, 48128
    buffer_load_dwordx4 v14, s[24:27], s48 offen lds
    s_waitcnt vmcnt(32)
    s_barrier
    s_mov_b32 m0, 16384
    s_add_u32 s48, s47, 32768
    buffer_load_dwordx4 v15, s[28:31], s48 offen lds
    s_mov_b32 m0, 17408
    s_add_u32 s48, s47, 33792
    buffer_load_dwordx4 v16, s[28:31], s48 offen lds
    s_mov_b32 m0, 18432
    s_add_u32 s48, s47, 34816
    buffer_load_dwordx4 v15, s[28:31], s48 offen lds
    s_mov_b32 m0, 19456
    s_add_u32 s48, s47, 35840
    buffer_load_dwordx4 v16, s[28:31], s48 offen lds
    s_mov_b32 m0, 20480
    s_add_u32 s48, s47, 36864
    buffer_load_dwordx4 v15, s[28:31], s48 offen lds
    s_mov_b32 m0, 21504
    s_add_u32 s48, s47, 37888
    buffer_load_dwordx4 v16, s[28:31], s48 offen lds
    s_mov_b32 m0, 22528
    s_add_u32 s48, s47, 38912
    buffer_load_dwordx4 v15, s[28:31], s48 offen lds
    s_mov_b32 m0, 23552
    s_add_u32 s48, s47, 39936
    buffer_load_dwordx4 v16, s[28:31], s48 offen lds
    s_mov_b32 m0, 24576
    s_add_u32 s48, s47, 40960
    buffer_load_dwordx4 v15, s[28:31], s48 offen lds
    s_mov_b32 m0, 25600
    s_add_u32 s48, s47, 41984
    buffer_load_dwordx4 v16, s[28:31], s48 offen lds
    s_mov_b32 m0, 26624
    s_add_u32 s48, s47, 43008
    buffer_load_dwordx4 v15, s[28:31], s48 offen lds
    s_mov_b32 m0, 27648
    s_add_u32 s48, s47, 44032
    buffer_load_dwordx4 v16, s[28:31], s48 offen lds
    s_mov_b32 m0, 28672
    s_add_u32 s48, s47, 45056
    buffer_load_dwordx4 v15, s[28:31], s48 offen lds
    s_mov_b32 m0, 29696
    s_add_u32 s48, s47, 46080
    buffer_load_dwordx4 v16, s[28:31], s48 offen lds
    s_mov_b32 m0, 30720
    s_add_u32 s48, s47, 47104
    buffer_load_dwordx4 v15, s[28:31], s48 offen lds
    s_mov_b32 m0, 31744
    s_add_u32 s48, s47, 48128
    buffer_load_dwordx4 v16, s[28:31], s48 offen lds
    s_waitcnt vmcnt(32)
    s_barrier
    s_mov_b32 m0, 32768
    s_add_u32 s48, s47, 49152
    buffer_load_dwordx4 v11, s[24:27], s48 offen lds
    s_mov_b32 m0, 33792
    s_add_u32 s48, s47, 50176
    buffer_load_dwordx4 v12, s[24:27], s48 offen lds
    s_mov_b32 m0, 34816
    s_add_u32 s48, s47, 51200
    buffer_load_dwordx4 v13, s[24:27], s48 offen lds
    s_mov_b32 m0, 35840
    s_add_u32 s48, s47, 52224
    buffer_load_dwordx4 v14, s[24:27], s48 offen lds
    s_mov_b32 m0, 36864
    s_add_u32 s48, s47, 53248
    buffer_load_dwordx4 v11, s[24:27], s48 offen lds
    s_mov_b32 m0, 37888
    s_add_u32 s48, s47, 54272
    buffer_load_dwordx4 v12, s[24:27], s48 offen lds
    s_mov_b32 m0, 38912
    s_add_u32 s48, s47, 55296
    buffer_load_dwordx4 v13, s[24:27], s48 offen lds
    s_mov_b32 m0, 39936
    s_add_u32 s48, s47, 56320
    buffer_load_dwordx4 v14, s[24:27], s48 offen lds
    s_mov_b32 m0, 40960
    s_add_u32 s48, s47, 57344
    buffer_load_dwordx4 v11, s[24:27], s48 offen lds
    s_mov_b32 m0, 41984
    s_add_u32 s48, s47, 58368
    buffer_load_dwordx4 v12, s[24:27], s48 offen lds
    s_mov_b32 m0, 43008
    s_add_u32 s48, s47, 59392
    buffer_load_dwordx4 v13, s[24:27], s48 offen lds
    s_mov_b32 m0, 44032
    s_add_u32 s48, s47, 60416
    buffer_load_dwordx4 v14, s[24:27], s48 offen lds
    s_mov_b32 m0, 45056
    s_add_u32 s48, s47, 61440
    buffer_load_dwordx4 v11, s[24:27], s48 offen lds
    s_mov_b32 m0, 46080
    s_add_u32 s48, s47, 62464
    buffer_load_dwordx4 v12, s[24:27], s48 offen lds
    s_mov_b32 m0, 47104
    s_add_u32 s48, s47, 63488
    buffer_load_dwordx4 v13, s[24:27], s48 offen lds
    s_mov_b32 m0, 48128
    s_add_u32 s48, s47, 64512
    buffer_load_dwordx4 v14, s[24:27], s48 offen lds
    s_waitcnt vmcnt(32)
    s_barrier
    s_mov_b32 m0, 49152
    s_add_u32 s48, s47, 49152
    buffer_load_dwordx4 v15, s[28:31], s48 offen lds
    s_mov_b32 m0, 50176
    s_add_u32 s48, s47, 50176
    buffer_load_dwordx4 v16, s[28:31], s48 offen lds
    s_mov_b32 m0, 51200
    s_add_u32 s48, s47, 51200
    buffer_load_dwordx4 v15, s[28:31], s48 offen lds
    s_mov_b32 m0, 52224
    s_add_u32 s48, s47, 52224
    buffer_load_dwordx4 v16, s[28:31], s48 offen lds
    s_mov_b32 m0, 53248
    s_add_u32 s48, s47, 53248
    buffer_load_dwordx4 v15, s[28:31], s48 offen lds
    s_mov_b32 m0, 54272
    s_add_u32 s48, s47, 54272
    buffer_load_dwordx4 v16, s[28:31], s48 offen lds
    s_mov_b32 m0, 55296
    s_add_u32 s48, s47, 55296
    buffer_load_dwordx4 v15, s[28:31], s48 offen lds
    s_mov_b32 m0, 56320
    s_add_u32 s48, s47, 56320
    buffer_load_dwordx4 v16, s[28:31], s48 offen lds
    s_mov_b32 m0, 57344
    s_add_u32 s48, s47, 57344
    buffer_load_dwordx4 v15, s[28:31], s48 offen lds
    s_mov_b32 m0, 58368
    s_add_u32 s48, s47, 58368
    buffer_load_dwordx4 v16, s[28:31], s48 offen lds
    s_mov_b32 m0, 59392
    s_add_u32 s48, s47, 59392
    buffer_load_dwordx4 v15, s[28:31], s48 offen lds
    s_mov_b32 m0, 60416
    s_add_u32 s48, s47, 60416
    buffer_load_dwordx4 v16, s[28:31], s48 offen lds
    s_mov_b32 m0, 61440
    s_add_u32 s48, s47, 61440
    buffer_load_dwordx4 v15, s[28:31], s48 offen lds
    s_mov_b32 m0, 62464
    s_add_u32 s48, s47, 62464
    buffer_load_dwordx4 v16, s[28:31], s48 offen lds
    s_mov_b32 m0, 63488
    s_add_u32 s48, s47, 63488
    buffer_load_dwordx4 v15, s[28:31], s48 offen lds
    s_mov_b32 m0, 64512
    s_add_u32 s48, s47, 64512
    buffer_load_dwordx4 v16, s[28:31], s48 offen lds
    s_waitcnt vmcnt(32)
    s_barrier
    s_mov_b32 m0, 0
    s_add_u32 s48, s47, 65536
    buffer_load_dwordx4 v11, s[24:27], s48 offen lds
    s_mov_b32 m0, 1024
    s_add_u32 s48, s47, 66560
    buffer_load_dwordx4 v12, s[24:27], s48 offen lds
    s_mov_b32 m0, 2048
    s_add_u32 s48, s47, 67584
    buffer_load_dwordx4 v13, s[24:27], s48 offen lds
    s_mov_b32 m0, 3072
    s_add_u32 s48, s47, 68608
    buffer_load_dwordx4 v14, s[24:27], s48 offen lds
    s_mov_b32 m0, 4096
    s_add_u32 s48, s47, 69632
    buffer_load_dwordx4 v11, s[24:27], s48 offen lds
    s_mov_b32 m0, 5120
    s_add_u32 s48, s47, 70656
    buffer_load_dwordx4 v12, s[24:27], s48 offen lds
    s_mov_b32 m0, 6144
    s_add_u32 s48, s47, 71680
    buffer_load_dwordx4 v13, s[24:27], s48 offen lds
    s_mov_b32 m0, 7168
    s_add_u32 s48, s47, 72704
    buffer_load_dwordx4 v14, s[24:27], s48 offen lds
    s_mov_b32 m0, 8192
    s_add_u32 s48, s47, 73728
    buffer_load_dwordx4 v11, s[24:27], s48 offen lds
    s_mov_b32 m0, 9216
    s_add_u32 s48, s47, 74752
    buffer_load_dwordx4 v12, s[24:27], s48 offen lds
    s_mov_b32 m0, 10240
    s_add_u32 s48, s47, 75776
    buffer_load_dwordx4 v13, s[24:27], s48 offen lds
    s_mov_b32 m0, 11264
    s_add_u32 s48, s47, 76800
    buffer_load_dwordx4 v14, s[24:27], s48 offen lds
    s_mov_b32 m0, 12288
    s_add_u32 s48, s47, 77824
    buffer_load_dwordx4 v11, s[24:27], s48 offen lds
    s_mov_b32 m0, 13312
    s_add_u32 s48, s47, 78848
    buffer_load_dwordx4 v12, s[24:27], s48 offen lds
    s_mov_b32 m0, 14336
    s_add_u32 s48, s47, 79872
    buffer_load_dwordx4 v13, s[24:27], s48 offen lds
    s_mov_b32 m0, 15360
    s_add_u32 s48, s47, 80896
    buffer_load_dwordx4 v14, s[24:27], s48 offen lds
    s_waitcnt vmcnt(32)
    s_barrier
    s_mov_b32 m0, 16384
    s_add_u32 s48, s47, 65536
    buffer_load_dwordx4 v15, s[28:31], s48 offen lds
    s_mov_b32 m0, 17408
    s_add_u32 s48, s47, 66560
    buffer_load_dwordx4 v16, s[28:31], s48 offen lds
    s_mov_b32 m0, 18432
    s_add_u32 s48, s47, 67584
    buffer_load_dwordx4 v15, s[28:31], s48 offen lds
    s_mov_b32 m0, 19456
    s_add_u32 s48, s47, 68608
    buffer_load_dwordx4 v16, s[28:31], s48 offen lds
    s_mov_b32 m0, 20480
    s_add_u32 s48, s47, 69632
    buffer_load_dwordx4 v15, s[28:31], s48 offen lds
    s_mov_b32 m0, 21504
    s_add_u32 s48, s47, 70656
    buffer_load_dwordx4 v16, s[28:31], s48 offen lds
    s_mov_b32 m0, 22528
    s_add_u32 s48, s47, 71680
    buffer_load_dwordx4 v15, s[28:31], s48 offen lds
    s_mov_b32 m0, 23552
    s_add_u32 s48, s47, 72704
    buffer_load_dwordx4 v16, s[28:31], s48 offen lds
    s_mov_b32 m0, 24576
    s_add_u32 s48, s47, 73728
    buffer_load_dwordx4 v15, s[28:31], s48 offen lds
    s_mov_b32 m0, 25600
    s_add_u32 s48, s47, 74752
    buffer_load_dwordx4 v16, s[28:31], s48 offen lds
    s_mov_b32 m0, 26624
    s_add_u32 s48, s47, 75776
    buffer_load_dwordx4 v15, s[28:31], s48 offen lds
    s_mov_b32 m0, 27648
    s_add_u32 s48, s47, 76800
    buffer_load_dwordx4 v16, s[28:31], s48 offen lds
    s_mov_b32 m0, 28672
    s_add_u32 s48, s47, 77824
    buffer_load_dwordx4 v15, s[28:31], s48 offen lds
    s_mov_b32 m0, 29696
    s_add_u32 s48, s47, 78848
    buffer_load_dwordx4 v16, s[28:31], s48 offen lds
    s_mov_b32 m0, 30720
    s_add_u32 s48, s47, 79872
    buffer_load_dwordx4 v15, s[28:31], s48 offen lds
    s_mov_b32 m0, 31744
    s_add_u32 s48, s47, 80896
    buffer_load_dwordx4 v16, s[28:31], s48 offen lds
    s_waitcnt vmcnt(32)
    s_barrier
    s_mov_b32 m0, 32768
    s_add_u32 s48, s47, 81920
    buffer_load_dwordx4 v11, s[24:27], s48 offen lds
    s_mov_b32 m0, 33792
    s_add_u32 s48, s47, 82944
    buffer_load_dwordx4 v12, s[24:27], s48 offen lds
    s_mov_b32 m0, 34816
    s_add_u32 s48, s47, 83968
    buffer_load_dwordx4 v13, s[24:27], s48 offen lds
    s_mov_b32 m0, 35840
    s_add_u32 s48, s47, 84992
    buffer_load_dwordx4 v14, s[24:27], s48 offen lds
    s_mov_b32 m0, 36864
    s_add_u32 s48, s47, 86016
    buffer_load_dwordx4 v11, s[24:27], s48 offen lds
    s_mov_b32 m0, 37888
    s_add_u32 s48, s47, 87040
    buffer_load_dwordx4 v12, s[24:27], s48 offen lds
    s_mov_b32 m0, 38912
    s_add_u32 s48, s47, 88064
    buffer_load_dwordx4 v13, s[24:27], s48 offen lds
    s_mov_b32 m0, 39936
    s_add_u32 s48, s47, 89088
    buffer_load_dwordx4 v14, s[24:27], s48 offen lds
    s_mov_b32 m0, 40960
    s_add_u32 s48, s47, 90112
    buffer_load_dwordx4 v11, s[24:27], s48 offen lds
    s_mov_b32 m0, 41984
    s_add_u32 s48, s47, 91136
    buffer_load_dwordx4 v12, s[24:27], s48 offen lds
    s_mov_b32 m0, 43008
    s_add_u32 s48, s47, 92160
    buffer_load_dwordx4 v13, s[24:27], s48 offen lds
    s_mov_b32 m0, 44032
    s_add_u32 s48, s47, 93184
    buffer_load_dwordx4 v14, s[24:27], s48 offen lds
    s_mov_b32 m0, 45056
    s_add_u32 s48, s47, 94208
    buffer_load_dwordx4 v11, s[24:27], s48 offen lds
    s_mov_b32 m0, 46080
    s_add_u32 s48, s47, 95232
    buffer_load_dwordx4 v12, s[24:27], s48 offen lds
    s_mov_b32 m0, 47104
    s_add_u32 s48, s47, 96256
    buffer_load_dwordx4 v13, s[24:27], s48 offen lds
    s_mov_b32 m0, 48128
    s_add_u32 s48, s47, 97280
    buffer_load_dwordx4 v14, s[24:27], s48 offen lds
    s_waitcnt vmcnt(32)
    s_barrier
    s_mov_b32 m0, 49152
    s_add_u32 s48, s47, 81920
    buffer_load_dwordx4 v15, s[28:31], s48 offen lds
    s_mov_b32 m0, 50176
    s_add_u32 s48, s47, 82944
    buffer_load_dwordx4 v16, s[28:31], s48 offen lds
    s_mov_b32 m0, 51200
    s_add_u32 s48, s47, 83968
    buffer_load_dwordx4 v15, s[28:31], s48 offen lds
    s_mov_b32 m0, 52224
    s_add_u32 s48, s47, 84992
    buffer_load_dwordx4 v16, s[28:31], s48 offen lds
    s_mov_b32 m0, 53248
    s_add_u32 s48, s47, 86016
    buffer_load_dwordx4 v15, s[28:31], s48 offen lds
    s_mov_b32 m0, 54272
    s_add_u32 s48, s47, 87040
    buffer_load_dwordx4 v16, s[28:31], s48 offen lds
    s_mov_b32 m0, 55296
    s_add_u32 s48, s47, 88064
    buffer_load_dwordx4 v15, s[28:31], s48 offen lds
    s_mov_b32 m0, 56320
    s_add_u32 s48, s47, 89088
    buffer_load_dwordx4 v16, s[28:31], s48 offen lds
    s_mov_b32 m0, 57344
    s_add_u32 s48, s47, 90112
    buffer_load_dwordx4 v15, s[28:31], s48 offen lds
    s_mov_b32 m0, 58368
    s_add_u32 s48, s47, 91136
    buffer_load_dwordx4 v16, s[28:31], s48 offen lds
    s_mov_b32 m0, 59392
    s_add_u32 s48, s47, 92160
    buffer_load_dwordx4 v15, s[28:31], s48 offen lds
    s_mov_b32 m0, 60416
    s_add_u32 s48, s47, 93184
    buffer_load_dwordx4 v16, s[28:31], s48 offen lds
    s_mov_b32 m0, 61440
    s_add_u32 s48, s47, 94208
    buffer_load_dwordx4 v15, s[28:31], s48 offen lds
    s_mov_b32 m0, 62464
    s_add_u32 s48, s47, 95232
    buffer_load_dwordx4 v16, s[28:31], s48 offen lds
    s_mov_b32 m0, 63488
    s_add_u32 s48, s47, 96256
    buffer_load_dwordx4 v15, s[28:31], s48 offen lds
    s_mov_b32 m0, 64512
    s_add_u32 s48, s47, 97280
    buffer_load_dwordx4 v16, s[28:31], s48 offen lds
    s_waitcnt vmcnt(32)
    s_barrier
    s_mov_b32 m0, 0
    s_add_u32 s48, s47, 98304
    buffer_load_dwordx4 v11, s[24:27], s48 offen lds
    s_mov_b32 m0, 1024
    s_add_u32 s48, s47, 99328
    buffer_load_dwordx4 v12, s[24:27], s48 offen lds
    s_mov_b32 m0, 2048
    s_add_u32 s48, s47, 100352
    buffer_load_dwordx4 v13, s[24:27], s48 offen lds
    s_mov_b32 m0, 3072
    s_add_u32 s48, s47, 101376
    buffer_load_dwordx4 v14, s[24:27], s48 offen lds
    s_mov_b32 m0, 4096
    s_add_u32 s48, s47, 102400
    buffer_load_dwordx4 v11, s[24:27], s48 offen lds
    s_mov_b32 m0, 5120
    s_add_u32 s48, s47, 103424
    buffer_load_dwordx4 v12, s[24:27], s48 offen lds
    s_mov_b32 m0, 6144
    s_add_u32 s48, s47, 104448
    buffer_load_dwordx4 v13, s[24:27], s48 offen lds
    s_mov_b32 m0, 7168
    s_add_u32 s48, s47, 105472
    buffer_load_dwordx4 v14, s[24:27], s48 offen lds
    s_mov_b32 m0, 8192
    s_add_u32 s48, s47, 106496
    buffer_load_dwordx4 v11, s[24:27], s48 offen lds
    s_mov_b32 m0, 9216
    s_add_u32 s48, s47, 107520
    buffer_load_dwordx4 v12, s[24:27], s48 offen lds
    s_mov_b32 m0, 10240
    s_add_u32 s48, s47, 108544
    buffer_load_dwordx4 v13, s[24:27], s48 offen lds
    s_mov_b32 m0, 11264
    s_add_u32 s48, s47, 109568
    buffer_load_dwordx4 v14, s[24:27], s48 offen lds
    s_mov_b32 m0, 12288
    s_add_u32 s48, s47, 110592
    buffer_load_dwordx4 v11, s[24:27], s48 offen lds
    s_mov_b32 m0, 13312
    s_add_u32 s48, s47, 111616
    buffer_load_dwordx4 v12, s[24:27], s48 offen lds
    s_mov_b32 m0, 14336
    s_add_u32 s48, s47, 112640
    buffer_load_dwordx4 v13, s[24:27], s48 offen lds
    s_mov_b32 m0, 15360
    s_add_u32 s48, s47, 113664
    buffer_load_dwordx4 v14, s[24:27], s48 offen lds
    s_waitcnt vmcnt(32)
    s_barrier
    s_mov_b32 m0, 16384
    s_add_u32 s48, s47, 98304
    buffer_load_dwordx4 v15, s[28:31], s48 offen lds
    s_mov_b32 m0, 17408
    s_add_u32 s48, s47, 99328
    buffer_load_dwordx4 v16, s[28:31], s48 offen lds
    s_mov_b32 m0, 18432
    s_add_u32 s48, s47, 100352
    buffer_load_dwordx4 v15, s[28:31], s48 offen lds
    s_mov_b32 m0, 19456
    s_add_u32 s48, s47, 101376
    buffer_load_dwordx4 v16, s[28:31], s48 offen lds
    s_mov_b32 m0, 20480
    s_add_u32 s48, s47, 102400
    buffer_load_dwordx4 v15, s[28:31], s48 offen lds
    s_mov_b32 m0, 21504
    s_add_u32 s48, s47, 103424
    buffer_load_dwordx4 v16, s[28:31], s48 offen lds
    s_mov_b32 m0, 22528
    s_add_u32 s48, s47, 104448
    buffer_load_dwordx4 v15, s[28:31], s48 offen lds
    s_mov_b32 m0, 23552
    s_add_u32 s48, s47, 105472
    buffer_load_dwordx4 v16, s[28:31], s48 offen lds
    s_mov_b32 m0, 24576
    s_add_u32 s48, s47, 106496
    buffer_load_dwordx4 v15, s[28:31], s48 offen lds
    s_mov_b32 m0, 25600
    s_add_u32 s48, s47, 107520
    buffer_load_dwordx4 v16, s[28:31], s48 offen lds
    s_mov_b32 m0, 26624
    s_add_u32 s48, s47, 108544
    buffer_load_dwordx4 v15, s[28:31], s48 offen lds
    s_mov_b32 m0, 27648
    s_add_u32 s48, s47, 109568
    buffer_load_dwordx4 v16, s[28:31], s48 offen lds
    s_mov_b32 m0, 28672
    s_add_u32 s48, s47, 110592
    buffer_load_dwordx4 v15, s[28:31], s48 offen lds
    s_mov_b32 m0, 29696
    s_add_u32 s48, s47, 111616
    buffer_load_dwordx4 v16, s[28:31], s48 offen lds
    s_mov_b32 m0, 30720
    s_add_u32 s48, s47, 112640
    buffer_load_dwordx4 v15, s[28:31], s48 offen lds
    s_mov_b32 m0, 31744
    s_add_u32 s48, s47, 113664
    buffer_load_dwordx4 v16, s[28:31], s48 offen lds
    s_waitcnt vmcnt(32)
    s_barrier
    s_mov_b32 m0, 32768
    s_add_u32 s48, s47, 114688
    buffer_load_dwordx4 v11, s[24:27], s48 offen lds
    s_mov_b32 m0, 33792
    s_add_u32 s48, s47, 115712
    buffer_load_dwordx4 v12, s[24:27], s48 offen lds
    s_mov_b32 m0, 34816
    s_add_u32 s48, s47, 116736
    buffer_load_dwordx4 v13, s[24:27], s48 offen lds
    s_mov_b32 m0, 35840
    s_add_u32 s48, s47, 117760
    buffer_load_dwordx4 v14, s[24:27], s48 offen lds
    s_mov_b32 m0, 36864
    s_add_u32 s48, s47, 118784
    buffer_load_dwordx4 v11, s[24:27], s48 offen lds
    s_mov_b32 m0, 37888
    s_add_u32 s48, s47, 119808
    buffer_load_dwordx4 v12, s[24:27], s48 offen lds
    s_mov_b32 m0, 38912
    s_add_u32 s48, s47, 120832
    buffer_load_dwordx4 v13, s[24:27], s48 offen lds
    s_mov_b32 m0, 39936
    s_add_u32 s48, s47, 121856
    buffer_load_dwordx4 v14, s[24:27], s48 offen lds
    s_mov_b32 m0, 40960
    s_add_u32 s48, s47, 122880
    buffer_load_dwordx4 v11, s[24:27], s48 offen lds
    s_mov_b32 m0, 41984
    s_add_u32 s48, s47, 123904
    buffer_load_dwordx4 v12, s[24:27], s48 offen lds
    s_mov_b32 m0, 43008
    s_add_u32 s48, s47, 124928
    buffer_load_dwordx4 v13, s[24:27], s48 offen lds
    s_mov_b32 m0, 44032
    s_add_u32 s48, s47, 125952
    buffer_load_dwordx4 v14, s[24:27], s48 offen lds
    s_mov_b32 m0, 45056
    s_add_u32 s48, s47, 126976
    buffer_load_dwordx4 v11, s[24:27], s48 offen lds
    s_mov_b32 m0, 46080
    s_add_u32 s48, s47, 128000
    buffer_load_dwordx4 v12, s[24:27], s48 offen lds
    s_mov_b32 m0, 47104
    s_add_u32 s48, s47, 129024
    buffer_load_dwordx4 v13, s[24:27], s48 offen lds
    s_mov_b32 m0, 48128
    s_add_u32 s48, s47, 130048
    buffer_load_dwordx4 v14, s[24:27], s48 offen lds
    s_waitcnt vmcnt(32)
    s_barrier
    s_mov_b32 m0, 49152
    s_add_u32 s48, s47, 114688
    buffer_load_dwordx4 v15, s[28:31], s48 offen lds
    s_mov_b32 m0, 50176
    s_add_u32 s48, s47, 115712
    buffer_load_dwordx4 v16, s[28:31], s48 offen lds
    s_mov_b32 m0, 51200
    s_add_u32 s48, s47, 116736
    buffer_load_dwordx4 v15, s[28:31], s48 offen lds
    s_mov_b32 m0, 52224
    s_add_u32 s48, s47, 117760
    buffer_load_dwordx4 v16, s[28:31], s48 offen lds
    s_mov_b32 m0, 53248
    s_add_u32 s48, s47, 118784
    buffer_load_dwordx4 v15, s[28:31], s48 offen lds
    s_mov_b32 m0, 54272
    s_add_u32 s48, s47, 119808
    buffer_load_dwordx4 v16, s[28:31], s48 offen lds
    s_mov_b32 m0, 55296
    s_add_u32 s48, s47, 120832
    buffer_load_dwordx4 v15, s[28:31], s48 offen lds
    s_mov_b32 m0, 56320
    s_add_u32 s48, s47, 121856
    buffer_load_dwordx4 v16, s[28:31], s48 offen lds
    s_mov_b32 m0, 57344
    s_add_u32 s48, s47, 122880
    buffer_load_dwordx4 v15, s[28:31], s48 offen lds
    s_mov_b32 m0, 58368
    s_add_u32 s48, s47, 123904
    buffer_load_dwordx4 v16, s[28:31], s48 offen lds
    s_mov_b32 m0, 59392
    s_add_u32 s48, s47, 124928
    buffer_load_dwordx4 v15, s[28:31], s48 offen lds
    s_mov_b32 m0, 60416
    s_add_u32 s48, s47, 125952
    buffer_load_dwordx4 v16, s[28:31], s48 offen lds
    s_mov_b32 m0, 61440
    s_add_u32 s48, s47, 126976
    buffer_load_dwordx4 v15, s[28:31], s48 offen lds
    s_mov_b32 m0, 62464
    s_add_u32 s48, s47, 128000
    buffer_load_dwordx4 v16, s[28:31], s48 offen lds
    s_mov_b32 m0, 63488
    s_add_u32 s48, s47, 129024
    buffer_load_dwordx4 v15, s[28:31], s48 offen lds
    s_mov_b32 m0, 64512
    s_add_u32 s48, s47, 130048
    buffer_load_dwordx4 v16, s[28:31], s48 offen lds
    s_waitcnt vmcnt(32)
    s_barrier
    s_waitcnt vmcnt(16)
    s_barrier
    s_waitcnt vmcnt(0)
    s_barrier
K1_END:
    s_endpgm
.globl mha_oproj_kernel
.p2align 8
.type mha_oproj_kernel,@function
mha_oproj_kernel:
    s_cmp_ge_u32 s2, 256
    s_cbranch_scc1 K2_END
    s_load_dwordx4 s[8:11], s[0:1], 32
    s_load_dwordx2 s[16:17], s[0:1], 56
    s_and_b32 s4, s2, 7
    s_lshl_b32 s4, s4, 2
    s_lshr_b32 s5, s2, 3
    s_and_b32 s5, s5, 3
    s_add_u32 s4, s4, s5
    s_lshr_b32 s5, s2, 5
    v_lshrrev_b32 v1, 6, v0
    s_nop 0
    v_readfirstlane_b32 s6, v1
    v_and_b32 v0, 63, v0
    s_waitcnt lgkmcnt(0)
    s_mov_b32 s20, s16
    s_and_b32 s21, s17, 0xffff
    s_mov_b32 s22, 37748736
    s_mov_b32 s23, 0x00020000
    s_mov_b32 s24, s8
    s_and_b32 s25, s9, 0xffff
    s_mov_b32 s26, 4194304
    s_mov_b32 s27, 0x00020000
    s_mov_b32 s28, s10
    s_and_b32 s29, s11, 0xffff
    s_mov_b32 s30, 4718592
    s_mov_b32 s31, 0x00020000
    s_cmp_eq_u32 s6, 3
    s_cbranch_scc1 K2_LOADER
    v_and_b32 v1, 15, v0
    v_lshrrev_b32 v2, 4, v0
    v_lshrrev_b32 v3, 2, v1
    v_and_b32 v4, 3, v1
    v_lshl_add_u32 v5, v2, 3, v3
    v_lshlrev_b32 v6, 1, v3
    v_lshrrev_b32 v7, 1, v4
    v_xor_b32 v6, v6, v7
    v_lshlrev_b32 v6, 4, v6
    v_and_b32 v7, 1, v4
    v_lshl_add_u32 v6, v7, 3, v6
    v_lshl_add_u32 v247, v5, 7, v6
    s_mul_i32 s7, s4, 144
    s_mul_i32 s18, s6, 48
    s_add_u32 s7, s7, s18
    v_add_u32 v3, s7, v1
    v_lshlrev_b32 v4, 13, v3
    v_lshl_add_u32 v248, v2, 4, v4
    v_lshlrev_b32 v4, 10, v3
    s_lshl_b32 s18, s5, 7
    v_add_u32 v4, s18, v4
    v_lshl_add_u32 v249, v2, 3, v4
    s_mov_b32 s41, 0
    s_mov_b32 s45, 0x20000
    s_mov_b32 s46, 0x40000
    v_mov_b32 v48, 0
    v_mov_b32 v49, 0
    v_mov_b32 v50, 0
    v_mov_b32 v51, 0
    v_mov_b32 v52, 0
    v_mov_b32 v53, 0
    v_mov_b32 v54, 0
    v_mov_b32 v55, 0
    v_mov_b32 v56, 0
    v_mov_b32 v57, 0
    v_mov_b32 v58, 0
    v_mov_b32 v59, 0
    v_mov_b32 v60, 0
    v_mov_b32 v61, 0
    v_mov_b32 v62, 0
    v_mov_b32 v63, 0
    v_mov_b32 v64, 0
    v_mov_b32 v65, 0
    v_mov_b32 v66, 0
    v_mov_b32 v67, 0
    v_mov_b32 v68, 0
    v_mov_b32 v69, 0
    v_mov_b32 v70, 0
    v_mov_b32 v71, 0
    v_mov_b32 v72, 0
    v_mov_b32 v73, 0
    v_mov_b32 v74, 0
    v_mov_b32 v75, 0
    v_mov_b32 v76, 0
    v_mov_b32 v77, 0
    v_mov_b32 v78, 0
    v_mov_b32 v79, 0
    v_mov_b32 v80, 0
    v_mov_b32 v81, 0
    v_mov_b32 v82, 0
    v_mov_b32 v83, 0
    v_mov_b32 v84, 0
    v_mov_b32 v85, 0
    v_mov_b32 v86, 0
    v_mov_b32 v87, 0
    v_mov_b32 v88, 0
    v_mov_b32 v89, 0
    v_mov_b32 v90, 0
    v_mov_b32 v91, 0
    v_mov_b32 v92, 0
    v_mov_b32 v93, 0
    v_mov_b32 v94, 0
    v_mov_b32 v95, 0
    s_mov_b32 s49, 0
    buffer_load_dwordx4 v[100:103], v248, s[20:23], s41 offen offset:0
    buffer_load_dwordx4 v[104:107], v248, s[20:23], s41 offen offset:64
    buffer_load_dwordx4 v[108:111], v248, s[20:23], s41 offen offset:128
    buffer_load_dwordx4 v[112:115], v248, s[20:23], s41 offen offset:192
    buffer_load_dwordx4 v[116:119], v248, s[20:23], s45 offen offset:0
    buffer_load_dwordx4 v[120:123], v248, s[20:23], s45 offen offset:64
    buffer_load_dwordx4 v[124:127], v248, s[20:23], s45 offen offset:128
    buffer_load_dwordx4 v[128:131], v248, s[20:23], s45 offen offset:192
    buffer_load_dwordx4 v[132:135], v248, s[20:23], s46 offen offset:0
    buffer_load_dwordx4 v[136:139], v248, s[20:23], s46 offen offset:64
    buffer_load_dwordx4 v[140:143], v248, s[20:23], s46 offen offset:128
    buffer_load_dwordx4 v[144:147], v248, s[20:23], s46 offen offset:192
    v_add_u32 v248, 256, v248
    s_mov_b32 s44, 8
K2_LOOP:
    s_barrier
    buffer_load_dwordx4 v[148:151], v248, s[20:23], s41 offen offset:0
    buffer_load_dwordx4 v[152:155], v248, s[20:23], s41 offen offset:64
    buffer_load_dwordx4 v[156:159], v248, s[20:23], s41 offen offset:128
    buffer_load_dwordx4 v[160:163], v248, s[20:23], s41 offen offset:192
    buffer_load_dwordx4 v[164:167], v248, s[20:23], s45 offen offset:0
    buffer_load_dwordx4 v[168:171], v248, s[20:23], s45 offen offset:64
    buffer_load_dwordx4 v[172:175], v248, s[20:23], s45 offen offset:128
    buffer_load_dwordx4 v[176:179], v248, s[20:23], s45 offen offset:192
    buffer_load_dwordx4 v[180:183], v248, s[20:23], s46 offen offset:0
    buffer_load_dwordx4 v[184:187], v248, s[20:23], s46 offen offset:64
    buffer_load_dwordx4 v[188:191], v248, s[20:23], s46 offen offset:128
    buffer_load_dwordx4 v[192:195], v248, s[20:23], s46 offen offset:192
    v_add_u32 v248, 256, v248
    s_waitcnt vmcnt(12)
    v_xor_b32 v241, 0, v247
    ds_read_b64_tr_b16 v[216:217], v241 offset:0
    ds_read_b64_tr_b16 v[218:219], v241 offset:512
    v_xor_b32 v241, 32, v247
    ds_read_b64_tr_b16 v[220:221], v241 offset:0
    ds_read_b64_tr_b16 v[222:223], v241 offset:512
    v_xor_b32 v241, 64, v247
    ds_read_b64_tr_b16 v[224:225], v241 offset:0
    ds_read_b64_tr_b16 v[226:227], v241 offset:512
    s_waitcnt lgkmcnt(4)
    v_mfma_f32_16x16x32_bf16 v[48:51], v[216:219], v[100:103], v[48:51]
    v_mfma_f32_16x16x32_bf16 v[52:55], v[216:219], v[116:119], v[52:55]
    v_mfma_f32_16x16x32_bf16 v[56:59], v[216:219], v[132:135], v[56:59]
    v_xor_b32 v241, 96, v247
    ds_read_b64_tr_b16 v[228:229], v241 offset:0
    ds_read_b64_tr_b16 v[230:231], v241 offset:512
    s_waitcnt lgkmcnt(4)
    v_mfma_f32_16x16x32_bf16 v[60:63], v[220:223], v[100:103], v[60:63]
    v_mfma_f32_16x16x32_bf16 v[64:67], v[220:223], v[116:119], v[64:67]
    v_mfma_f32_16x16x32_bf16 v[68:71], v[220:223], v[132:135], v[68:71]
    v_xor_b32 v241, 0, v247
    ds_read_b64_tr_b16 v[216:217], v241 offset:4096
    ds_read_b64_tr_b16 v[218:219], v241 offset:4608
    s_waitcnt lgkmcnt(4)
    v_mfma_f32_16x16x32_bf16 v[72:75], v[224:227], v[100:103], v[72:75]
    v_mfma_f32_16x16x32_bf16 v[76:79], v[224:227], v[116:119], v[76:79]
    v_mfma_f32_16x16x32_bf16 v[80:83], v[224:227], v[132:135], v[80:83]
    v_xor_b32 v241, 32, v247
    ds_read_b64_tr_b16 v[220:221], v241 offset:4096
    ds_read_b64_tr_b16 v[222:223], v241 offset:4608
    s_waitcnt lgkmcnt(4)
    v_mfma_f32_16x16x32_bf16 v[84:87], v[228:231], v[100:103], v[84:87]
    v_mfma_f32_16x16x32_bf16 v[88:91], v[228:231], v[116:119], v[88:91]
    v_mfma_f32_16x16x32_bf16 v[92:95], v[228:231], v[132:135], v[92:95]
    v_xor_b32 v241, 64, v247
    ds_read_b64_tr_b16 v[224:225], v241 offset:4096
    ds_read_b64_tr_b16 v[226:227], v241 offset:4608
    s_waitcnt lgkmcnt(4)
    v_mfma_f32_16x16x32_bf16 v[48:51], v[216:219], v[104:107], v[48:51]
    v_mfma_f32_16x16x32_bf16 v[52:55], v[216:219], v[120:123], v[52:55]
    v_mfma_f32_16x16x32_bf16 v[56:59], v[216:219], v[136:139], v[56:59]
    v_xor_b32 v241, 96, v247
    ds_read_b64_tr_b16 v[228:229], v241 offset:4096
    ds_read_b64_tr_b16 v[230:231], v241 offset:4608
    s_waitcnt lgkmcnt(4)
    v_mfma_f32_16x16x32_bf16 v[60:63], v[220:223], v[104:107], v[60:63]
    v_mfma_f32_16x16x32_bf16 v[64:67], v[220:223], v[120:123], v[64:67]
    v_mfma_f32_16x16x32_bf16 v[68:71], v[220:223], v[136:139], v[68:71]
    v_xor_b32 v241, 0, v247
    ds_read_b64_tr_b16 v[216:217], v241 offset:8192
    ds_read_b64_tr_b16 v[218:219], v241 offset:8704
    s_waitcnt lgkmcnt(4)
    v_mfma_f32_16x16x32_bf16 v[72:75], v[224:227], v[104:107], v[72:75]
    v_mfma_f32_16x16x32_bf16 v[76:79], v[224:227], v[120:123], v[76:79]
    v_mfma_f32_16x16x32_bf16 v[80:83], v[224:227], v[136:139], v[80:83]
    v_xor_b32 v241, 32, v247
    ds_read_b64_tr_b16 v[220:221], v241 offset:8192
    ds_read_b64_tr_b16 v[222:223], v241 offset:8704
    s_waitcnt lgkmcnt(4)
    v_mfma_f32_16x16x32_bf16 v[84:87], v[228:231], v[104:107], v[84:87]
    v_mfma_f32_16x16x32_bf16 v[88:91], v[228:231], v[120:123], v[88:91]
    v_mfma_f32_16x16x32_bf16 v[92:95], v[228:231], v[136:139], v[92:95]
    v_xor_b32 v241, 64, v247
    ds_read_b64_tr_b16 v[224:225], v241 offset:8192
    ds_read_b64_tr_b16 v[226:227], v241 offset:8704
    s_waitcnt lgkmcnt(4)
    v_mfma_f32_16x16x32_bf16 v[48:51], v[216:219], v[108:111], v[48:51]
    v_mfma_f32_16x16x32_bf16 v[52:55], v[216:219], v[124:127], v[52:55]
    v_mfma_f32_16x16x32_bf16 v[56:59], v[216:219], v[140:143], v[56:59]
    v_xor_b32 v241, 96, v247
    ds_read_b64_tr_b16 v[228:229], v241 offset:8192
    ds_read_b64_tr_b16 v[230:231], v241 offset:8704
    s_waitcnt lgkmcnt(4)
    v_mfma_f32_16x16x32_bf16 v[60:63], v[220:223], v[108:111], v[60:63]
    v_mfma_f32_16x16x32_bf16 v[64:67], v[220:223], v[124:127], v[64:67]
    v_mfma_f32_16x16x32_bf16 v[68:71], v[220:223], v[140:143], v[68:71]
    v_xor_b32 v241, 0, v247
    ds_read_b64_tr_b16 v[216:217], v241 offset:12288
    ds_read_b64_tr_b16 v[218:219], v241 offset:12800
    s_waitcnt lgkmcnt(4)
    v_mfma_f32_16x16x32_bf16 v[72:75], v[224:227], v[108:111], v[72:75]
    v_mfma_f32_16x16x32_bf16 v[76:79], v[224:227], v[124:127], v[76:79]
    v_mfma_f32_16x16x32_bf16 v[80:83], v[224:227], v[140:143], v[80:83]
    v_xor_b32 v241, 32, v247
    ds_read_b64_tr_b16 v[220:221], v241 offset:12288
    ds_read_b64_tr_b16 v[222:223], v241 offset:12800
    s_waitcnt lgkmcnt(4)
    v_mfma_f32_16x16x32_bf16 v[84:87], v[228:231], v[108:111], v[84:87]
    v_mfma_f32_16x16x32_bf16 v[88:91], v[228:231], v[124:127], v[88:91]
    v_mfma_f32_16x16x32_bf16 v[92:95], v[228:231], v[140:143], v[92:95]
    v_xor_b32 v241, 64, v247
    ds_read_b64_tr_b16 v[224:225], v241 offset:12288
    ds_read_b64_tr_b16 v[226:227], v241 offset:12800
    s_waitcnt lgkmcnt(4)
    v_mfma_f32_16x16x32_bf16 v[48:51], v[216:219], v[112:115], v[48:51]
    v_mfma_f32_16x16x32_bf16 v[52:55], v[216:219], v[128:131], v[52:55]
    v_mfma_f32_16x16x32_bf16 v[56:59], v[216:219], v[144:147], v[56:59]
    v_xor_b32 v241, 96, v247
    ds_read_b64_tr_b16 v[228:229], v241 offset:12288
    ds_read_b64_tr_b16 v[230:231], v241 offset:12800
    s_waitcnt lgkmcnt(4)
    v_mfma_f32_16x16x32_bf16 v[60:63], v[220:223], v[112:115], v[60:63]
    v_mfma_f32_16x16x32_bf16 v[64:67], v[220:223], v[128:131], v[64:67]
    v_mfma_f32_16x16x32_bf16 v[68:71], v[220:223], v[144:147], v[68:71]
    s_waitcnt lgkmcnt(2)
    v_mfma_f32_16x16x32_bf16 v[72:75], v[224:227], v[112:115], v[72:75]
    v_mfma_f32_16x16x32_bf16 v[76:79], v[224:227], v[128:131], v[76:79]
    v_mfma_f32_16x16x32_bf16 v[80:83], v[224:227], v[144:147], v[80:83]
    s_waitcnt lgkmcnt(0)
    v_mfma_f32_16x16x32_bf16 v[84:87], v[228:231], v[112:115], v[84:87]
    v_mfma_f32_16x16x32_bf16 v[88:91], v[228:231], v[128:131], v[88:91]
    v_mfma_f32_16x16x32_bf16 v[92:95], v[228:231], v[144:147], v[92:95]
    s_barrier
    buffer_load_dwordx4 v[100:103], v248, s[20:23], s41 offen offset:0
    buffer_load_dwordx4 v[104:107], v248, s[20:23], s41 offen offset:64
    buffer_load_dwordx4 v[108:111], v248, s[20:23], s41 offen offset:128
    buffer_load_dwordx4 v[112:115], v248, s[20:23], s41 offen offset:192
    buffer_load_dwordx4 v[116:119], v248, s[20:23], s45 offen offset:0
    buffer_load_dwordx4 v[120:123], v248, s[20:23], s45 offen offset:64
    buffer_load_dwordx4 v[124:127], v248, s[20:23], s45 offen offset:128
    buffer_load_dwordx4 v[128:131], v248, s[20:23], s45 offen offset:192
    buffer_load_dwordx4 v[132:135], v248, s[20:23], s46 offen offset:0
    buffer_load_dwordx4 v[136:139], v248, s[20:23], s46 offen offset:64
    buffer_load_dwordx4 v[140:143], v248, s[20:23], s46 offen offset:128
    buffer_load_dwordx4 v[144:147], v248, s[20:23], s46 offen offset:192
    v_add_u32 v248, 256, v248
    s_waitcnt vmcnt(12)
    v_xor_b32 v241, 0, v247
    ds_read_b64_tr_b16 v[216:217], v241 offset:16384
    ds_read_b64_tr_b16 v[218:219], v241 offset:16896
    v_xor_b32 v241, 32, v247
    ds_read_b64_tr_b16 v[220:221], v241 offset:16384
    ds_read_b64_tr_b16 v[222:223], v241 offset:16896
    v_xor_b32 v241, 64, v247
    ds_read_b64_tr_b16 v[224:225], v241 offset:16384
    ds_read_b64_tr_b16 v[226:227], v241 offset:16896
    s_waitcnt lgkmcnt(4)
    v_mfma_f32_16x16x32_bf16 v[48:51], v[216:219], v[148:151], v[48:51]
    v_mfma_f32_16x16x32_bf16 v[52:55], v[216:219], v[164:167], v[52:55]
    v_mfma_f32_16x16x32_bf16 v[56:59], v[216:219], v[180:183], v[56:59]
    v_xor_b32 v241, 96, v247
    ds_read_b64_tr_b16 v[228:229], v241 offset:16384
    ds_read_b64_tr_b16 v[230:231], v241 offset:16896
    s_waitcnt lgkmcnt(4)
    v_mfma_f32_16x16x32_bf16 v[60:63], v[220:223], v[148:151], v[60:63]
    v_mfma_f32_16x16x32_bf16 v[64:67], v[220:223], v[164:167], v[64:67]
    v_mfma_f32_16x16x32_bf16 v[68:71], v[220:223], v[180:183], v[68:71]
    v_xor_b32 v241, 0, v247
    ds_read_b64_tr_b16 v[216:217], v241 offset:20480
    ds_read_b64_tr_b16 v[218:219], v241 offset:20992
    s_waitcnt lgkmcnt(4)
    v_mfma_f32_16x16x32_bf16 v[72:75], v[224:227], v[148:151], v[72:75]
    v_mfma_f32_16x16x32_bf16 v[76:79], v[224:227], v[164:167], v[76:79]
    v_mfma_f32_16x16x32_bf16 v[80:83], v[224:227], v[180:183], v[80:83]
    v_xor_b32 v241, 32, v247
    ds_read_b64_tr_b16 v[220:221], v241 offset:20480
    ds_read_b64_tr_b16 v[222:223], v241 offset:20992
    s_waitcnt lgkmcnt(4)
    v_mfma_f32_16x16x32_bf16 v[84:87], v[228:231], v[148:151], v[84:87]
    v_mfma_f32_16x16x32_bf16 v[88:91], v[228:231], v[164:167], v[88:91]
    v_mfma_f32_16x16x32_bf16 v[92:95], v[228:231], v[180:183], v[92:95]
    v_xor_b32 v241, 64, v247
    ds_read_b64_tr_b16 v[224:225], v241 offset:20480
    ds_read_b64_tr_b16 v[226:227], v241 offset:20992
    s_waitcnt lgkmcnt(4)
    v_mfma_f32_16x16x32_bf16 v[48:51], v[216:219], v[152:155], v[48:51]
    v_mfma_f32_16x16x32_bf16 v[52:55], v[216:219], v[168:171], v[52:55]
    v_mfma_f32_16x16x32_bf16 v[56:59], v[216:219], v[184:187], v[56:59]
    v_xor_b32 v241, 96, v247
    ds_read_b64_tr_b16 v[228:229], v241 offset:20480
    ds_read_b64_tr_b16 v[230:231], v241 offset:20992
    s_waitcnt lgkmcnt(4)
    v_mfma_f32_16x16x32_bf16 v[60:63], v[220:223], v[152:155], v[60:63]
    v_mfma_f32_16x16x32_bf16 v[64:67], v[220:223], v[168:171], v[64:67]
    v_mfma_f32_16x16x32_bf16 v[68:71], v[220:223], v[184:187], v[68:71]
    v_xor_b32 v241, 0, v247
    ds_read_b64_tr_b16 v[216:217], v241 offset:24576
    ds_read_b64_tr_b16 v[218:219], v241 offset:25088
    s_waitcnt lgkmcnt(4)
    v_mfma_f32_16x16x32_bf16 v[72:75], v[224:227], v[152:155], v[72:75]
    v_mfma_f32_16x16x32_bf16 v[76:79], v[224:227], v[168:171], v[76:79]
    v_mfma_f32_16x16x32_bf16 v[80:83], v[224:227], v[184:187], v[80:83]
    v_xor_b32 v241, 32, v247
    ds_read_b64_tr_b16 v[220:221], v241 offset:24576
    ds_read_b64_tr_b16 v[222:223], v241 offset:25088
    s_waitcnt lgkmcnt(4)
    v_mfma_f32_16x16x32_bf16 v[84:87], v[228:231], v[152:155], v[84:87]
    v_mfma_f32_16x16x32_bf16 v[88:91], v[228:231], v[168:171], v[88:91]
    v_mfma_f32_16x16x32_bf16 v[92:95], v[228:231], v[184:187], v[92:95]
    v_xor_b32 v241, 64, v247
    ds_read_b64_tr_b16 v[224:225], v241 offset:24576
    ds_read_b64_tr_b16 v[226:227], v241 offset:25088
    s_waitcnt lgkmcnt(4)
    v_mfma_f32_16x16x32_bf16 v[48:51], v[216:219], v[156:159], v[48:51]
    v_mfma_f32_16x16x32_bf16 v[52:55], v[216:219], v[172:175], v[52:55]
    v_mfma_f32_16x16x32_bf16 v[56:59], v[216:219], v[188:191], v[56:59]
    v_xor_b32 v241, 96, v247
    ds_read_b64_tr_b16 v[228:229], v241 offset:24576
    ds_read_b64_tr_b16 v[230:231], v241 offset:25088
    s_waitcnt lgkmcnt(4)
    v_mfma_f32_16x16x32_bf16 v[60:63], v[220:223], v[156:159], v[60:63]
    v_mfma_f32_16x16x32_bf16 v[64:67], v[220:223], v[172:175], v[64:67]
    v_mfma_f32_16x16x32_bf16 v[68:71], v[220:223], v[188:191], v[68:71]
    v_xor_b32 v241, 0, v247
    ds_read_b64_tr_b16 v[216:217], v241 offset:28672
    ds_read_b64_tr_b16 v[218:219], v241 offset:29184
    s_waitcnt lgkmcnt(4)
    v_mfma_f32_16x16x32_bf16 v[72:75], v[224:227], v[156:159], v[72:75]
    v_mfma_f32_16x16x32_bf16 v[76:79], v[224:227], v[172:175], v[76:79]
    v_mfma_f32_16x16x32_bf16 v[80:83], v[224:227], v[188:191], v[80:83]
    v_xor_b32 v241, 32, v247
    ds_read_b64_tr_b16 v[220:221], v241 offset:28672
    ds_read_b64_tr_b16 v[222:223], v241 offset:29184
    s_waitcnt lgkmcnt(4)
    v_mfma_f32_16x16x32_bf16 v[84:87], v[228:231], v[156:159], v[84:87]
    v_mfma_f32_16x16x32_bf16 v[88:91], v[228:231], v[172:175], v[88:91]
    v_mfma_f32_16x16x32_bf16 v[92:95], v[228:231], v[188:191], v[92:95]
    v_xor_b32 v241, 64, v247
    ds_read_b64_tr_b16 v[224:225], v241 offset:28672
    ds_read_b64_tr_b16 v[226:227], v241 offset:29184
    s_waitcnt lgkmcnt(4)
    v_mfma_f32_16x16x32_bf16 v[48:51], v[216:219], v[160:163], v[48:51]
    v_mfma_f32_16x16x32_bf16 v[52:55], v[216:219], v[176:179], v[52:55]
    v_mfma_f32_16x16x32_bf16 v[56:59], v[216:219], v[192:195], v[56:59]
    v_xor_b32 v241, 96, v247
    ds_read_b64_tr_b16 v[228:229], v241 offset:28672
    ds_read_b64_tr_b16 v[230:231], v241 offset:29184
    s_waitcnt lgkmcnt(4)
    v_mfma_f32_16x16x32_bf16 v[60:63], v[220:223], v[160:163], v[60:63]
    v_mfma_f32_16x16x32_bf16 v[64:67], v[220:223], v[176:179], v[64:67]
    v_mfma_f32_16x16x32_bf16 v[68:71], v[220:223], v[192:195], v[68:71]
    s_waitcnt lgkmcnt(2)
    v_mfma_f32_16x16x32_bf16 v[72:75], v[224:227], v[160:163], v[72:75]
    v_mfma_f32_16x16x32_bf16 v[76:79], v[224:227], v[176:179], v[76:79]
    v_mfma_f32_16x16x32_bf16 v[80:83], v[224:227], v[192:195], v[80:83]
    s_waitcnt lgkmcnt(0)
    v_mfma_f32_16x16x32_bf16 v[84:87], v[228:231], v[160:163], v[84:87]
    v_mfma_f32_16x16x32_bf16 v[88:91], v[228:231], v[176:179], v[88:91]
    v_mfma_f32_16x16x32_bf16 v[92:95], v[228:231], v[192:195], v[92:95]
    s_barrier
    buffer_load_dwordx4 v[148:151], v248, s[20:23], s41 offen offset:0
    buffer_load_dwordx4 v[152:155], v248, s[20:23], s41 offen offset:64
    buffer_load_dwordx4 v[156:159], v248, s[20:23], s41 offen offset:128
    buffer_load_dwordx4 v[160:163], v248, s[20:23], s41 offen offset:192
    buffer_load_dwordx4 v[164:167], v248, s[20:23], s45 offen offset:0
    buffer_load_dwordx4 v[168:171], v248, s[20:23], s45 offen offset:64
    buffer_load_dwordx4 v[172:175], v248, s[20:23], s45 offen offset:128
    buffer_load_dwordx4 v[176:179], v248, s[20:23], s45 offen offset:192
    buffer_load_dwordx4 v[180:183], v248, s[20:23], s46 offen offset:0
    buffer_load_dwordx4 v[184:187], v248, s[20:23], s46 offen offset:64
    buffer_load_dwordx4 v[188:191], v248, s[20:23], s46 offen offset:128
    buffer_load_dwordx4 v[192:195], v248, s[20:23], s46 offen offset:192
    v_add_u32 v248, 256, v248
    s_waitcnt vmcnt(12)
    v_xor_b32 v241, 0, v247
    ds_read_b64_tr_b16 v[216:217], v241 offset:32768
    ds_read_b64_tr_b16 v[218:219], v241 offset:33280
    v_xor_b32 v241, 32, v247
    ds_read_b64_tr_b16 v[220:221], v241 offset:32768
    ds_read_b64_tr_b16 v[222:223], v241 offset:33280
    v_xor_b32 v241, 64, v247
    ds_read_b64_tr_b16 v[224:225], v241 offset:32768
    ds_read_b64_tr_b16 v[226:227], v241 offset:33280
    s_waitcnt lgkmcnt(4)
    v_mfma_f32_16x16x32_bf16 v[48:51], v[216:219], v[100:103], v[48:51]
    v_mfma_f32_16x16x32_bf16 v[52:55], v[216:219], v[116:119], v[52:55]
    v_mfma_f32_16x16x32_bf16 v[56:59], v[216:219], v[132:135], v[56:59]
    v_xor_b32 v241, 96, v247
    ds_read_b64_tr_b16 v[228:229], v241 offset:32768
    ds_read_b64_tr_b16 v[230:231], v241 offset:33280
    s_waitcnt lgkmcnt(4)
    v_mfma_f32_16x16x32_bf16 v[60:63], v[220:223], v[100:103], v[60:63]
    v_mfma_f32_16x16x32_bf16 v[64:67], v[220:223], v[116:119], v[64:67]
    v_mfma_f32_16x16x32_bf16 v[68:71], v[220:223], v[132:135], v[68:71]
    v_xor_b32 v241, 0, v247
    ds_read_b64_tr_b16 v[216:217], v241 offset:36864
    ds_read_b64_tr_b16 v[218:219], v241 offset:37376
    s_waitcnt lgkmcnt(4)
    v_mfma_f32_16x16x32_bf16 v[72:75], v[224:227], v[100:103], v[72:75]
    v_mfma_f32_16x16x32_bf16 v[76:79], v[224:227], v[116:119], v[76:79]
    v_mfma_f32_16x16x32_bf16 v[80:83], v[224:227], v[132:135], v[80:83]
    v_xor_b32 v241, 32, v247
    ds_read_b64_tr_b16 v[220:221], v241 offset:36864
    ds_read_b64_tr_b16 v[222:223], v241 offset:37376
    s_waitcnt lgkmcnt(4)
    v_mfma_f32_16x16x32_bf16 v[84:87], v[228:231], v[100:103], v[84:87]
    v_mfma_f32_16x16x32_bf16 v[88:91], v[228:231], v[116:119], v[88:91]
    v_mfma_f32_16x16x32_bf16 v[92:95], v[228:231], v[132:135], v[92:95]
    v_xor_b32 v241, 64, v247
    ds_read_b64_tr_b16 v[224:225], v241 offset:36864
    ds_read_b64_tr_b16 v[226:227], v241 offset:37376
    s_waitcnt lgkmcnt(4)
    v_mfma_f32_16x16x32_bf16 v[48:51], v[216:219], v[104:107], v[48:51]
    v_mfma_f32_16x16x32_bf16 v[52:55], v[216:219], v[120:123], v[52:55]
    v_mfma_f32_16x16x32_bf16 v[56:59], v[216:219], v[136:139], v[56:59]
    v_xor_b32 v241, 96, v247
    ds_read_b64_tr_b16 v[228:229], v241 offset:36864
    ds_read_b64_tr_b16 v[230:231], v241 offset:37376
    s_waitcnt lgkmcnt(4)
    v_mfma_f32_16x16x32_bf16 v[60:63], v[220:223], v[104:107], v[60:63]
    v_mfma_f32_16x16x32_bf16 v[64:67], v[220:223], v[120:123], v[64:67]
    v_mfma_f32_16x16x32_bf16 v[68:71], v[220:223], v[136:139], v[68:71]
    v_xor_b32 v241, 0, v247
    ds_read_b64_tr_b16 v[216:217], v241 offset:40960
    ds_read_b64_tr_b16 v[218:219], v241 offset:41472
    s_waitcnt lgkmcnt(4)
    v_mfma_f32_16x16x32_bf16 v[72:75], v[224:227], v[104:107], v[72:75]
    v_mfma_f32_16x16x32_bf16 v[76:79], v[224:227], v[120:123], v[76:79]
    v_mfma_f32_16x16x32_bf16 v[80:83], v[224:227], v[136:139], v[80:83]
    v_xor_b32 v241, 32, v247
    ds_read_b64_tr_b16 v[220:221], v241 offset:40960
    ds_read_b64_tr_b16 v[222:223], v241 offset:41472
    s_waitcnt lgkmcnt(4)
    v_mfma_f32_16x16x32_bf16 v[84:87], v[228:231], v[104:107], v[84:87]
    v_mfma_f32_16x16x32_bf16 v[88:91], v[228:231], v[120:123], v[88:91]
    v_mfma_f32_16x16x32_bf16 v[92:95], v[228:231], v[136:139], v[92:95]
    v_xor_b32 v241, 64, v247
    ds_read_b64_tr_b16 v[224:225], v241 offset:40960
    ds_read_b64_tr_b16 v[226:227], v241 offset:41472
    s_waitcnt lgkmcnt(4)
    v_mfma_f32_16x16x32_bf16 v[48:51], v[216:219], v[108:111], v[48:51]
    v_mfma_f32_16x16x32_bf16 v[52:55], v[216:219], v[124:127], v[52:55]
    v_mfma_f32_16x16x32_bf16 v[56:59], v[216:219], v[140:143], v[56:59]
    v_xor_b32 v241, 96, v247
    ds_read_b64_tr_b16 v[228:229], v241 offset:40960
    ds_read_b64_tr_b16 v[230:231], v241 offset:41472
    s_waitcnt lgkmcnt(4)
    v_mfma_f32_16x16x32_bf16 v[60:63], v[220:223], v[108:111], v[60:63]
    v_mfma_f32_16x16x32_bf16 v[64:67], v[220:223], v[124:127], v[64:67]
    v_mfma_f32_16x16x32_bf16 v[68:71], v[220:223], v[140:143], v[68:71]
    v_xor_b32 v241, 0, v247
    ds_read_b64_tr_b16 v[216:217], v241 offset:45056
    ds_read_b64_tr_b16 v[218:219], v241 offset:45568
    s_waitcnt lgkmcnt(4)
    v_mfma_f32_16x16x32_bf16 v[72:75], v[224:227], v[108:111], v[72:75]
    v_mfma_f32_16x16x32_bf16 v[76:79], v[224:227], v[124:127], v[76:79]
    v_mfma_f32_16x16x32_bf16 v[80:83], v[224:227], v[140:143], v[80:83]
    v_xor_b32 v241, 32, v247
    ds_read_b64_tr_b16 v[220:221], v241 offset:45056
    ds_read_b64_tr_b16 v[222:223], v241 offset:45568
    s_waitcnt lgkmcnt(4)
    v_mfma_f32_16x16x32_bf16 v[84:87], v[228:231], v[108:111], v[84:87]
    v_mfma_f32_16x16x32_bf16 v[88:91], v[228:231], v[124:127], v[88:91]
    v_mfma_f32_16x16x32_bf16 v[92:95], v[228:231], v[140:143], v[92:95]
    v_xor_b32 v241, 64, v247
    ds_read_b64_tr_b16 v[224:225], v241 offset:45056
    ds_read_b64_tr_b16 v[226:227], v241 offset:45568
    s_waitcnt lgkmcnt(4)
    v_mfma_f32_16x16x32_bf16 v[48:51], v[216:219], v[112:115], v[48:51]
    v_mfma_f32_16x16x32_bf16 v[52:55], v[216:219], v[128:131], v[52:55]
    v_mfma_f32_16x16x32_bf16 v[56:59], v[216:219], v[144:147], v[56:59]
    v_xor_b32 v241, 96, v247
    ds_read_b64_tr_b16 v[228:229], v241 offset:45056
    ds_read_b64_tr_b16 v[230:231], v241 offset:45568
    s_waitcnt lgkmcnt(4)
    v_mfma_f32_16x16x32_bf16 v[60:63], v[220:223], v[112:115], v[60:63]
    v_mfma_f32_16x16x32_bf16 v[64:67], v[220:223], v[128:131], v[64:67]
    v_mfma_f32_16x16x32_bf16 v[68:71], v[220:223], v[144:147], v[68:71]
    s_waitcnt lgkmcnt(2)
    v_mfma_f32_16x16x32_bf16 v[72:75], v[224:227], v[112:115], v[72:75]
    v_mfma_f32_16x16x32_bf16 v[76:79], v[224:227], v[128:131], v[76:79]
    v_mfma_f32_16x16x32_bf16 v[80:83], v[224:227], v[144:147], v[80:83]
    s_waitcnt lgkmcnt(0)
    v_mfma_f32_16x16x32_bf16 v[84:87], v[228:231], v[112:115], v[84:87]
    v_mfma_f32_16x16x32_bf16 v[88:91], v[228:231], v[128:131], v[88:91]
    v_mfma_f32_16x16x32_bf16 v[92:95], v[228:231], v[144:147], v[92:95]
    s_barrier
    buffer_load_dwordx4 v[100:103], v248, s[20:23], s41 offen offset:0
    buffer_load_dwordx4 v[104:107], v248, s[20:23], s41 offen offset:64
    buffer_load_dwordx4 v[108:111], v248, s[20:23], s41 offen offset:128
    buffer_load_dwordx4 v[112:115], v248, s[20:23], s41 offen offset:192
    buffer_load_dwordx4 v[116:119], v248, s[20:23], s45 offen offset:0
    buffer_load_dwordx4 v[120:123], v248, s[20:23], s45 offen offset:64
    buffer_load_dwordx4 v[124:127], v248, s[20:23], s45 offen offset:128
    buffer_load_dwordx4 v[128:131], v248, s[20:23], s45 offen offset:192
    buffer_load_dwordx4 v[132:135], v248, s[20:23], s46 offen offset:0
    buffer_load_dwordx4 v[136:139], v248, s[20:23], s46 offen offset:64
    buffer_load_dwordx4 v[140:143], v248, s[20:23], s46 offen offset:128
    buffer_load_dwordx4 v[144:147], v248, s[20:23], s46 offen offset:192
    v_add_u32 v248, 256, v248
    s_waitcnt vmcnt(12)
    v_xor_b32 v241, 0, v247
    ds_read_b64_tr_b16 v[216:217], v241 offset:49152
    ds_read_b64_tr_b16 v[218:219], v241 offset:49664
    v_xor_b32 v241, 32, v247
    ds_read_b64_tr_b16 v[220:221], v241 offset:49152
    ds_read_b64_tr_b16 v[222:223], v241 offset:49664
    v_xor_b32 v241, 64, v247
    ds_read_b64_tr_b16 v[224:225], v241 offset:49152
    ds_read_b64_tr_b16 v[226:227], v241 offset:49664
    s_waitcnt lgkmcnt(4)
    v_mfma_f32_16x16x32_bf16 v[48:51], v[216:219], v[148:151], v[48:51]
    v_mfma_f32_16x16x32_bf16 v[52:55], v[216:219], v[164:167], v[52:55]
    v_mfma_f32_16x16x32_bf16 v[56:59], v[216:219], v[180:183], v[56:59]
    v_xor_b32 v241, 96, v247
    ds_read_b64_tr_b16 v[228:229], v241 offset:49152
    ds_read_b64_tr_b16 v[230:231], v241 offset:49664
    s_waitcnt lgkmcnt(4)
    v_mfma_f32_16x16x32_bf16 v[60:63], v[220:223], v[148:151], v[60:63]
    v_mfma_f32_16x16x32_bf16 v[64:67], v[220:223], v[164:167], v[64:67]
    v_mfma_f32_16x16x32_bf16 v[68:71], v[220:223], v[180:183], v[68:71]
    v_xor_b32 v241, 0, v247
    ds_read_b64_tr_b16 v[216:217], v241 offset:53248
    ds_read_b64_tr_b16 v[218:219], v241 offset:53760
    s_waitcnt lgkmcnt(4)
    v_mfma_f32_16x16x32_bf16 v[72:75], v[224:227], v[148:151], v[72:75]
    v_mfma_f32_16x16x32_bf16 v[76:79], v[224:227], v[164:167], v[76:79]
    v_mfma_f32_16x16x32_bf16 v[80:83], v[224:227], v[180:183], v[80:83]
    v_xor_b32 v241, 32, v247
    ds_read_b64_tr_b16 v[220:221], v241 offset:53248
    ds_read_b64_tr_b16 v[222:223], v241 offset:53760
    s_waitcnt lgkmcnt(4)
    v_mfma_f32_16x16x32_bf16 v[84:87], v[228:231], v[148:151], v[84:87]
    v_mfma_f32_16x16x32_bf16 v[88:91], v[228:231], v[164:167], v[88:91]
    v_mfma_f32_16x16x32_bf16 v[92:95], v[228:231], v[180:183], v[92:95]
    v_xor_b32 v241, 64, v247
    ds_read_b64_tr_b16 v[224:225], v241 offset:53248
    ds_read_b64_tr_b16 v[226:227], v241 offset:53760
    s_waitcnt lgkmcnt(4)
    v_mfma_f32_16x16x32_bf16 v[48:51], v[216:219], v[152:155], v[48:51]
    v_mfma_f32_16x16x32_bf16 v[52:55], v[216:219], v[168:171], v[52:55]
    v_mfma_f32_16x16x32_bf16 v[56:59], v[216:219], v[184:187], v[56:59]
    v_xor_b32 v241, 96, v247
    ds_read_b64_tr_b16 v[228:229], v241 offset:53248
    ds_read_b64_tr_b16 v[230:231], v241 offset:53760
    s_waitcnt lgkmcnt(4)
    v_mfma_f32_16x16x32_bf16 v[60:63], v[220:223], v[152:155], v[60:63]
    v_mfma_f32_16x16x32_bf16 v[64:67], v[220:223], v[168:171], v[64:67]
    v_mfma_f32_16x16x32_bf16 v[68:71], v[220:223], v[184:187], v[68:71]
    v_xor_b32 v241, 0, v247
    ds_read_b64_tr_b16 v[216:217], v241 offset:57344
    ds_read_b64_tr_b16 v[218:219], v241 offset:57856
    s_waitcnt lgkmcnt(4)
    v_mfma_f32_16x16x32_bf16 v[72:75], v[224:227], v[152:155], v[72:75]
    v_mfma_f32_16x16x32_bf16 v[76:79], v[224:227], v[168:171], v[76:79]
    v_mfma_f32_16x16x32_bf16 v[80:83], v[224:227], v[184:187], v[80:83]
    v_xor_b32 v241, 32, v247
    ds_read_b64_tr_b16 v[220:221], v241 offset:57344
    ds_read_b64_tr_b16 v[222:223], v241 offset:57856
    s_waitcnt lgkmcnt(4)
    v_mfma_f32_16x16x32_bf16 v[84:87], v[228:231], v[152:155], v[84:87]
    v_mfma_f32_16x16x32_bf16 v[88:91], v[228:231], v[168:171], v[88:91]
    v_mfma_f32_16x16x32_bf16 v[92:95], v[228:231], v[184:187], v[92:95]
    v_xor_b32 v241, 64, v247
    ds_read_b64_tr_b16 v[224:225], v241 offset:57344
    ds_read_b64_tr_b16 v[226:227], v241 offset:57856
    s_waitcnt lgkmcnt(4)
    v_mfma_f32_16x16x32_bf16 v[48:51], v[216:219], v[156:159], v[48:51]
    v_mfma_f32_16x16x32_bf16 v[52:55], v[216:219], v[172:175], v[52:55]
    v_mfma_f32_16x16x32_bf16 v[56:59], v[216:219], v[188:191], v[56:59]
    v_xor_b32 v241, 96, v247
    ds_read_b64_tr_b16 v[228:229], v241 offset:57344
    ds_read_b64_tr_b16 v[230:231], v241 offset:57856
    s_waitcnt lgkmcnt(4)
    v_mfma_f32_16x16x32_bf16 v[60:63], v[220:223], v[156:159], v[60:63]
    v_mfma_f32_16x16x32_bf16 v[64:67], v[220:223], v[172:175], v[64:67]
    v_mfma_f32_16x16x32_bf16 v[68:71], v[220:223], v[188:191], v[68:71]
    v_xor_b32 v241, 0, v247
    ds_read_b64_tr_b16 v[216:217], v241 offset:61440
    ds_read_b64_tr_b16 v[218:219], v241 offset:61952
    s_waitcnt lgkmcnt(4)
    v_mfma_f32_16x16x32_bf16 v[72:75], v[224:227], v[156:159], v[72:75]
    v_mfma_f32_16x16x32_bf16 v[76:79], v[224:227], v[172:175], v[76:79]
    v_mfma_f32_16x16x32_bf16 v[80:83], v[224:227], v[188:191], v[80:83]
    v_xor_b32 v241, 32, v247
    ds_read_b64_tr_b16 v[220:221], v241 offset:61440
    ds_read_b64_tr_b16 v[222:223], v241 offset:61952
    s_waitcnt lgkmcnt(4)
    v_mfma_f32_16x16x32_bf16 v[84:87], v[228:231], v[156:159], v[84:87]
    v_mfma_f32_16x16x32_bf16 v[88:91], v[228:231], v[172:175], v[88:91]
    v_mfma_f32_16x16x32_bf16 v[92:95], v[228:231], v[188:191], v[92:95]
    v_xor_b32 v241, 64, v247
    ds_read_b64_tr_b16 v[224:225], v241 offset:61440
    ds_read_b64_tr_b16 v[226:227], v241 offset:61952
    s_waitcnt lgkmcnt(4)
    v_mfma_f32_16x16x32_bf16 v[48:51], v[216:219], v[160:163], v[48:51]
    v_mfma_f32_16x16x32_bf16 v[52:55], v[216:219], v[176:179], v[52:55]
    v_mfma_f32_16x16x32_bf16 v[56:59], v[216:219], v[192:195], v[56:59]
    v_xor_b32 v241, 96, v247
    ds_read_b64_tr_b16 v[228:229], v241 offset:61440
    ds_read_b64_tr_b16 v[230:231], v241 offset:61952
    s_waitcnt lgkmcnt(4)
    v_mfma_f32_16x16x32_bf16 v[60:63], v[220:223], v[160:163], v[60:63]
    v_mfma_f32_16x16x32_bf16 v[64:67], v[220:223], v[176:179], v[64:67]
    v_mfma_f32_16x16x32_bf16 v[68:71], v[220:223], v[192:195], v[68:71]
    s_waitcnt lgkmcnt(2)
    v_mfma_f32_16x16x32_bf16 v[72:75], v[224:227], v[160:163], v[72:75]
    v_mfma_f32_16x16x32_bf16 v[76:79], v[224:227], v[176:179], v[76:79]
    v_mfma_f32_16x16x32_bf16 v[80:83], v[224:227], v[192:195], v[80:83]
    s_waitcnt lgkmcnt(0)
    v_mfma_f32_16x16x32_bf16 v[84:87], v[228:231], v[160:163], v[84:87]
    v_mfma_f32_16x16x32_bf16 v[88:91], v[228:231], v[176:179], v[88:91]
    v_mfma_f32_16x16x32_bf16 v[92:95], v[228:231], v[192:195], v[92:95]
    s_sub_u32 s44, s44, 1
    s_cmp_lg_u32 s44, 0
    s_cbranch_scc1 K2_LOOP
    s_nop 7
    s_nop 1
    s_mov_b32 s45, 0x4000
    s_mov_b32 s46, 0x8000
    v_cvt_pk_bf16_f32 v48, v48, v49
    v_cvt_pk_bf16_f32 v49, v50, v51
    buffer_store_dwordx2 v[48:49], v249, s[28:31], s41 offen offset:0
    v_cvt_pk_bf16_f32 v60, v60, v61
    v_cvt_pk_bf16_f32 v61, v62, v63
    buffer_store_dwordx2 v[60:61], v249, s[28:31], s41 offen offset:32
    v_cvt_pk_bf16_f32 v72, v72, v73
    v_cvt_pk_bf16_f32 v73, v74, v75
    buffer_store_dwordx2 v[72:73], v249, s[28:31], s41 offen offset:64
    v_cvt_pk_bf16_f32 v84, v84, v85
    v_cvt_pk_bf16_f32 v85, v86, v87
    buffer_store_dwordx2 v[84:85], v249, s[28:31], s41 offen offset:96
    v_cvt_pk_bf16_f32 v52, v52, v53
    v_cvt_pk_bf16_f32 v53, v54, v55
    buffer_store_dwordx2 v[52:53], v249, s[28:31], s45 offen offset:0
    v_cvt_pk_bf16_f32 v64, v64, v65
    v_cvt_pk_bf16_f32 v65, v66, v67
    buffer_store_dwordx2 v[64:65], v249, s[28:31], s45 offen offset:32
    v_cvt_pk_bf16_f32 v76, v76, v77
    v_cvt_pk_bf16_f32 v77, v78, v79
    buffer_store_dwordx2 v[76:77], v249, s[28:31], s45 offen offset:64
    v_cvt_pk_bf16_f32 v88, v88, v89
    v_cvt_pk_bf16_f32 v89, v90, v91
    buffer_store_dwordx2 v[88:89], v249, s[28:31], s45 offen offset:96
    v_cvt_pk_bf16_f32 v56, v56, v57
    v_cvt_pk_bf16_f32 v57, v58, v59
    buffer_store_dwordx2 v[56:57], v249, s[28:31], s46 offen offset:0
    v_cvt_pk_bf16_f32 v68, v68, v69
    v_cvt_pk_bf16_f32 v69, v70, v71
    buffer_store_dwordx2 v[68:69], v249, s[28:31], s46 offen offset:32
    v_cvt_pk_bf16_f32 v80, v80, v81
    v_cvt_pk_bf16_f32 v81, v82, v83
    buffer_store_dwordx2 v[80:81], v249, s[28:31], s46 offen offset:64
    v_cvt_pk_bf16_f32 v92, v92, v93
    v_cvt_pk_bf16_f32 v93, v94, v95
    buffer_store_dwordx2 v[92:93], v249, s[28:31], s46 offen offset:96
    s_endpgm
K2_LOADER:
    v_and_b32 v1, 7, v0
    v_lshrrev_b32 v2, 3, v0
    v_and_b32 v3, 3, v2
    v_lshlrev_b32 v3, 1, v3
    v_xor_b32 v3, v3, v1
    v_lshlrev_b32 v3, 4, v3
    v_lshl_add_u32 v3, v2, 10, v3
    s_lshl_b32 s18, s5, 7
    v_add_u32 v10, s18, v3
    s_mov_b32 m0, 0
    s_mov_b32 s48, 0
    buffer_load_dwordx4 v10, s[24:27], s48 offen lds
    s_mov_b32 m0, 1024
    s_mov_b32 s48, 8192
    buffer_load_dwordx4 v10, s[24:27], s48 offen lds
    s_mov_b32 m0, 2048
    s_mov_b32 s48, 16384
    buffer_load_dwordx4 v10, s[24:27], s48 offen lds
    s_mov_b32 m0, 3072
    s_mov_b32 s48, 24576
    buffer_load_dwordx4 v10, s[24:27], s48 offen lds
    s_mov_b32 m0, 4096
    s_mov_b32 s48, 32768
    buffer_load_dwordx4 v10, s[24:27], s48 offen lds
    s_mov_b32 m0, 5120
    s_mov_b32 s48, 40960
    buffer_load_dwordx4 v10, s[24:27], s48 offen lds
    s_mov_b32 m0, 6144
    s_mov_b32 s48, 49152
    buffer_load_dwordx4 v10, s[24:27], s48 offen lds
    s_mov_b32 m0, 7168
    s_mov_b32 s48, 57344
    buffer_load_dwordx4 v10, s[24:27], s48 offen lds
    s_mov_b32 m0, 8192
    s_mov_b32 s48, 65536
    buffer_load_dwordx4 v10, s[24:27], s48 offen lds
    s_mov_b32 m0, 9216
    s_mov_b32 s48, 73728
    buffer_load_dwordx4 v10, s[24:27], s48 offen lds
    s_mov_b32 m0, 10240
    s_mov_b32 s48, 81920
    buffer_load_dwordx4 v10, s[24:27], s48 offen lds
    s_mov_b32 m0, 11264
    s_mov_b32 s48, 90112
    buffer_load_dwordx4 v10, s[24:27], s48 offen lds
    s_mov_b32 m0, 12288
    s_mov_b32 s48, 98304
    buffer_load_dwordx4 v10, s[24:27], s48 offen lds
    s_mov_b32 m0, 13312
    s_mov_b32 s48, 106496
    buffer_load_dwordx4 v10, s[24:27], s48 offen lds
    s_mov_b32 m0, 14336
    s_mov_b32 s48, 114688
    buffer_load_dwordx4 v10, s[24:27], s48 offen lds
    s_mov_b32 m0, 15360
    s_mov_b32 s48, 122880
    buffer_load_dwordx4 v10, s[24:27], s48 offen lds
    s_mov_b32 m0, 16384
    s_mov_b32 s48, 131072
    buffer_load_dwordx4 v10, s[24:27], s48 offen lds
    s_mov_b32 m0, 17408
    s_mov_b32 s48, 139264
    buffer_load_dwordx4 v10, s[24:27], s48 offen lds
    s_mov_b32 m0, 18432
    s_mov_b32 s48, 147456
    buffer_load_dwordx4 v10, s[24:27], s48 offen lds
    s_mov_b32 m0, 19456
    s_mov_b32 s48, 155648
    buffer_load_dwordx4 v10, s[24:27], s48 offen lds
    s_mov_b32 m0, 20480
    s_mov_b32 s48, 163840
    buffer_load_dwordx4 v10, s[24:27], s48 offen lds
    s_mov_b32 m0, 21504
    s_mov_b32 s48, 172032
    buffer_load_dwordx4 v10, s[24:27], s48 offen lds
    s_mov_b32 m0, 22528
    s_mov_b32 s48, 180224
    buffer_load_dwordx4 v10, s[24:27], s48 offen lds
    s_mov_b32 m0, 23552
    s_mov_b32 s48, 188416
    buffer_load_dwordx4 v10, s[24:27], s48 offen lds
    s_mov_b32 m0, 24576
    s_mov_b32 s48, 196608
    buffer_load_dwordx4 v10, s[24:27], s48 offen lds
    s_mov_b32 m0, 25600
    s_mov_b32 s48, 204800
    buffer_load_dwordx4 v10, s[24:27], s48 offen lds
    s_mov_b32 m0, 26624
    s_mov_b32 s48, 212992
    buffer_load_dwordx4 v10, s[24:27], s48 offen lds
    s_mov_b32 m0, 27648
    s_mov_b32 s48, 221184
    buffer_load_dwordx4 v10, s[24:27], s48 offen lds
    s_mov_b32 m0, 28672
    s_mov_b32 s48, 229376
    buffer_load_dwordx4 v10, s[24:27], s48 offen lds
    s_mov_b32 m0, 29696
    s_mov_b32 s48, 237568
    buffer_load_dwordx4 v10, s[24:27], s48 offen lds
    s_mov_b32 m0, 30720
    s_mov_b32 s48, 245760
    buffer_load_dwordx4 v10, s[24:27], s48 offen lds
    s_mov_b32 m0, 31744
    s_mov_b32 s48, 253952
    buffer_load_dwordx4 v10, s[24:27], s48 offen lds
    s_mov_b32 m0, 32768
    s_mov_b32 s48, 262144
    buffer_load_dwordx4 v10, s[24:27], s48 offen lds
    s_mov_b32 m0, 33792
    s_mov_b32 s48, 270336
    buffer_load_dwordx4 v10, s[24:27], s48 offen lds
    s_mov_b32 m0, 34816
    s_mov_b32 s48, 278528
    buffer_load_dwordx4 v10, s[24:27], s48 offen lds
    s_mov_b32 m0, 35840
    s_mov_b32 s48, 286720
    buffer_load_dwordx4 v10, s[24:27], s48 offen lds
    s_mov_b32 m0, 36864
    s_mov_b32 s48, 294912
    buffer_load_dwordx4 v10, s[24:27], s48 offen lds
    s_mov_b32 m0, 37888
    s_mov_b32 s48, 303104
    buffer_load_dwordx4 v10, s[24:27], s48 offen lds
    s_mov_b32 m0, 38912
    s_mov_b32 s48, 311296
    buffer_load_dwordx4 v10, s[24:27], s48 offen lds
    s_mov_b32 m0, 39936
    s_mov_b32 s48, 319488
    buffer_load_dwordx4 v10, s[24:27], s48 offen lds
    s_mov_b32 m0, 40960
    s_mov_b32 s48, 327680
    buffer_load_dwordx4 v10, s[24:27], s48 offen lds
    s_mov_b32 m0, 41984
    s_mov_b32 s48, 335872
    buffer_load_dwordx4 v10, s[24:27], s48 offen lds
    s_mov_b32 m0, 43008
    s_mov_b32 s48, 344064
    buffer_load_dwordx4 v10, s[24:27], s48 offen lds
    s_mov_b32 m0, 44032
    s_mov_b32 s48, 352256
    buffer_load_dwordx4 v10, s[24:27], s48 offen lds
    s_mov_b32 m0, 45056
    s_mov_b32 s48, 360448
    buffer_load_dwordx4 v10, s[24:27], s48 offen lds
    s_mov_b32 m0, 46080
    s_mov_b32 s48, 368640
    buffer_load_dwordx4 v10, s[24:27], s48 offen lds
    s_mov_b32 m0, 47104
    s_mov_b32 s48, 376832
    buffer_load_dwordx4 v10, s[24:27], s48 offen lds
    s_mov_b32 m0, 48128
    s_mov_b32 s48, 385024
    buffer_load_dwordx4 v10, s[24:27], s48 offen lds
    s_waitcnt vmcnt(32)
    s_barrier
    s_mov_b32 m0, 49152
    s_mov_b32 s48, 393216
    buffer_load_dwordx4 v10, s[24:27], s48 offen lds
    s_mov_b32 m0, 50176
    s_mov_b32 s48, 401408
    buffer_load_dwordx4 v10, s[24:27], s48 offen lds
    s_mov_b32 m0, 51200
    s_mov_b32 s48, 409600
    buffer_load_dwordx4 v10, s[24:27], s48 offen lds
    s_mov_b32 m0, 52224
    s_mov_b32 s48, 417792
    buffer_load_dwordx4 v10, s[24:27], s48 offen lds
    s_mov_b32 m0, 53248
    s_mov_b32 s48, 425984
    buffer_load_dwordx4 v10, s[24:27], s48 offen lds
    s_mov_b32 m0, 54272
    s_mov_b32 s48, 434176
    buffer_load_dwordx4 v10, s[24:27], s48 offen lds
    s_mov_b32 m0, 55296
    s_mov_b32 s48, 442368
    buffer_load_dwordx4 v10, s[24:27], s48 offen lds
    s_mov_b32 m0, 56320
    s_mov_b32 s48, 450560
    buffer_load_dwordx4 v10, s[24:27], s48 offen lds
    s_mov_b32 m0, 57344
    s_mov_b32 s48, 458752
    buffer_load_dwordx4 v10, s[24:27], s48 offen lds
    s_mov_b32 m0, 58368
    s_mov_b32 s48, 466944
    buffer_load_dwordx4 v10, s[24:27], s48 offen lds
    s_mov_b32 m0, 59392
    s_mov_b32 s48, 475136
    buffer_load_dwordx4 v10, s[24:27], s48 offen lds
    s_mov_b32 m0, 60416
    s_mov_b32 s48, 483328
    buffer_load_dwordx4 v10, s[24:27], s48 offen lds
    s_mov_b32 m0, 61440
    s_mov_b32 s48, 491520
    buffer_load_dwordx4 v10, s[24:27], s48 offen lds
    s_mov_b32 m0, 62464
    s_mov_b32 s48, 499712
    buffer_load_dwordx4 v10, s[24:27], s48 offen lds
    s_mov_b32 m0, 63488
    s_mov_b32 s48, 507904
    buffer_load_dwordx4 v10, s[24:27], s48 offen lds
    s_mov_b32 m0, 64512
    s_mov_b32 s48, 516096
    buffer_load_dwordx4 v10, s[24:27], s48 offen lds
    s_waitcnt vmcnt(32)
    s_barrier
    s_mov_b32 m0, 0
    s_mov_b32 s48, 524288
    buffer_load_dwordx4 v10, s[24:27], s48 offen lds
    s_mov_b32 m0, 1024
    s_mov_b32 s48, 532480
    buffer_load_dwordx4 v10, s[24:27], s48 offen lds
    s_mov_b32 m0, 2048
    s_mov_b32 s48, 540672
    buffer_load_dwordx4 v10, s[24:27], s48 offen lds
    s_mov_b32 m0, 3072
    s_mov_b32 s48, 548864
    buffer_load_dwordx4 v10, s[24:27], s48 offen lds
    s_mov_b32 m0, 4096
    s_mov_b32 s48, 557056
    buffer_load_dwordx4 v10, s[24:27], s48 offen lds
    s_mov_b32 m0, 5120
    s_mov_b32 s48, 565248
    buffer_load_dwordx4 v10, s[24:27], s48 offen lds
    s_mov_b32 m0, 6144
    s_mov_b32 s48, 573440
    buffer_load_dwordx4 v10, s[24:27], s48 offen lds
    s_mov_b32 m0, 7168
    s_mov_b32 s48, 581632
    buffer_load_dwordx4 v10, s[24:27], s48 offen lds
    s_mov_b32 m0, 8192
    s_mov_b32 s48, 589824
    buffer_load_dwordx4 v10, s[24:27], s48 offen lds
    s_mov_b32 m0, 9216
    s_mov_b32 s48, 598016
    buffer_load_dwordx4 v10, s[24:27], s48 offen lds
    s_mov_b32 m0, 10240
    s_mov_b32 s48, 606208
    buffer_load_dwordx4 v10, s[24:27], s48 offen lds
    s_mov_b32 m0, 11264
    s_mov_b32 s48, 614400
    buffer_load_dwordx4 v10, s[24:27], s48 offen lds
    s_mov_b32 m0, 12288
    s_mov_b32 s48, 622592
    buffer_load_dwordx4 v10, s[24:27], s48 offen lds
    s_mov_b32 m0, 13312
    s_mov_b32 s48, 630784
    buffer_load_dwordx4 v10, s[24:27], s48 offen lds
    s_mov_b32 m0, 14336
    s_mov_b32 s48, 638976
    buffer_load_dwordx4 v10, s[24:27], s48 offen lds
    s_mov_b32 m0, 15360
    s_mov_b32 s48, 647168
    buffer_load_dwordx4 v10, s[24:27], s48 offen lds
    s_waitcnt vmcnt(32)
    s_barrier
    s_mov_b32 m0, 16384
    s_mov_b32 s48, 655360
    buffer_load_dwordx4 v10, s[24:27], s48 offen lds
    s_mov_b32 m0, 17408
    s_mov_b32 s48, 663552
    buffer_load_dwordx4 v10, s[24:27], s48 offen lds
    s_mov_b32 m0, 18432
    s_mov_b32 s48, 671744
    buffer_load_dwordx4 v10, s[24:27], s48 offen lds
    s_mov_b32 m0, 19456
    s_mov_b32 s48, 679936
    buffer_load_dwordx4 v10, s[24:27], s48 offen lds
    s_mov_b32 m0, 20480
    s_mov_b32 s48, 688128
    buffer_load_dwordx4 v10, s[24:27], s48 offen lds
    s_mov_b32 m0, 21504
    s_mov_b32 s48, 696320
    buffer_load_dwordx4 v10, s[24:27], s48 offen lds
    s_mov_b32 m0, 22528
    s_mov_b32 s48, 704512
    buffer_load_dwordx4 v10, s[24:27], s48 offen lds
    s_mov_b32 m0, 23552
    s_mov_b32 s48, 712704
    buffer_load_dwordx4 v10, s[24:27], s48 offen lds
    s_mov_b32 m0, 24576
    s_mov_b32 s48, 720896
    buffer_load_dwordx4 v10, s[24:27], s48 offen lds
    s_mov_b32 m0, 25600
    s_mov_b32 s48, 729088
    buffer_load_dwordx4 v10, s[24:27], s48 offen lds
    s_mov_b32 m0, 26624
    s_mov_b32 s48, 737280
    buffer_load_dwordx4 v10, s[24:27], s48 offen lds
    s_mov_b32 m0, 27648
    s_mov_b32 s48, 745472
    buffer_load_dwordx4 v10, s[24:27], s48 offen lds
    s_mov_b32 m0, 28672
    s_mov_b32 s48, 753664
    buffer_load_dwordx4 v10, s[24:27], s48 offen lds
    s_mov_b32 m0, 29696
    s_mov_b32 s48, 761856
    buffer_load_dwordx4 v10, s[24:27], s48 offen lds
    s_mov_b32 m0, 30720
    s_mov_b32 s48, 770048
    buffer_load_dwordx4 v10, s[24:27], s48 offen lds
    s_mov_b32 m0, 31744
    s_mov_b32 s48, 778240
    buffer_load_dwordx4 v10, s[24:27], s48 offen lds
    s_waitcnt vmcnt(32)
    s_barrier
    s_mov_b32 m0, 32768
    s_mov_b32 s48, 786432
    buffer_load_dwordx4 v10, s[24:27], s48 offen lds
    s_mov_b32 m0, 33792
    s_mov_b32 s48, 794624
    buffer_load_dwordx4 v10, s[24:27], s48 offen lds
    s_mov_b32 m0, 34816
    s_mov_b32 s48, 802816
    buffer_load_dwordx4 v10, s[24:27], s48 offen lds
    s_mov_b32 m0, 35840
    s_mov_b32 s48, 811008
    buffer_load_dwordx4 v10, s[24:27], s48 offen lds
    s_mov_b32 m0, 36864
    s_mov_b32 s48, 819200
    buffer_load_dwordx4 v10, s[24:27], s48 offen lds
    s_mov_b32 m0, 37888
    s_mov_b32 s48, 827392
    buffer_load_dwordx4 v10, s[24:27], s48 offen lds
    s_mov_b32 m0, 38912
    s_mov_b32 s48, 835584
    buffer_load_dwordx4 v10, s[24:27], s48 offen lds
    s_mov_b32 m0, 39936
    s_mov_b32 s48, 843776
    buffer_load_dwordx4 v10, s[24:27], s48 offen lds
    s_mov_b32 m0, 40960
    s_mov_b32 s48, 851968
    buffer_load_dwordx4 v10, s[24:27], s48 offen lds
    s_mov_b32 m0, 41984
    s_mov_b32 s48, 860160
    buffer_load_dwordx4 v10, s[24:27], s48 offen lds
    s_mov_b32 m0, 43008
    s_mov_b32 s48, 868352
    buffer_load_dwordx4 v10, s[24:27], s48 offen lds
    s_mov_b32 m0, 44032
    s_mov_b32 s48, 876544
    buffer_load_dwordx4 v10, s[24:27], s48 offen lds
    s_mov_b32 m0, 45056
    s_mov_b32 s48, 884736
    buffer_load_dwordx4 v10, s[24:27], s48 offen lds
    s_mov_b32 m0, 46080
    s_mov_b32 s48, 892928
    buffer_load_dwordx4 v10, s[24:27], s48 offen lds
    s_mov_b32 m0, 47104
    s_mov_b32 s48, 901120
    buffer_load_dwordx4 v10, s[24:27], s48 offen lds
    s_mov_b32 m0, 48128
    s_mov_b32 s48, 909312
    buffer_load_dwordx4 v10, s[24:27], s48 offen lds
    s_waitcnt vmcnt(32)
    s_barrier
    s_mov_b32 m0, 49152
    s_mov_b32 s48, 917504
    buffer_load_dwordx4 v10, s[24:27], s48 offen lds
    s_mov_b32 m0, 50176
    s_mov_b32 s48, 925696
    buffer_load_dwordx4 v10, s[24:27], s48 offen lds
    s_mov_b32 m0, 51200
    s_mov_b32 s48, 933888
    buffer_load_dwordx4 v10, s[24:27], s48 offen lds
    s_mov_b32 m0, 52224
    s_mov_b32 s48, 942080
    buffer_load_dwordx4 v10, s[24:27], s48 offen lds
    s_mov_b32 m0, 53248
    s_mov_b32 s48, 950272
    buffer_load_dwordx4 v10, s[24:27], s48 offen lds
    s_mov_b32 m0, 54272
    s_mov_b32 s48, 958464
    buffer_load_dwordx4 v10, s[24:27], s48 offen lds
    s_mov_b32 m0, 55296
    s_mov_b32 s48, 966656
    buffer_load_dwordx4 v10, s[24:27], s48 offen lds
    s_mov_b32 m0, 56320
    s_mov_b32 s48, 974848
    buffer_load_dwordx4 v10, s[24:27], s48 offen lds
    s_mov_b32 m0, 57344
    s_mov_b32 s48, 983040
    buffer_load_dwordx4 v10, s[24:27], s48 offen lds
    s_mov_b32 m0, 58368
    s_mov_b32 s48, 991232
    buffer_load_dwordx4 v10, s[24:27], s48 offen lds
    s_mov_b32 m0, 59392
    s_mov_b32 s48, 999424
    buffer_load_dwordx4 v10, s[24:27], s48 offen lds
    s_mov_b32 m0, 60416
    s_mov_b32 s48, 1007616
    buffer_load_dwordx4 v10, s[24:27], s48 offen lds
    s_mov_b32 m0, 61440
    s_mov_b32 s48, 1015808
    buffer_load_dwordx4 v10, s[24:27], s48 offen lds
    s_mov_b32 m0, 62464
    s_mov_b32 s48, 1024000
    buffer_load_dwordx4 v10, s[24:27], s48 offen lds
    s_mov_b32 m0, 63488
    s_mov_b32 s48, 1032192
    buffer_load_dwordx4 v10, s[24:27], s48 offen lds
    s_mov_b32 m0, 64512
    s_mov_b32 s48, 1040384
    buffer_load_dwordx4 v10, s[24:27], s48 offen lds
    s_waitcnt vmcnt(32)
    s_barrier
    s_mov_b32 m0, 0
    s_mov_b32 s48, 1048576
    buffer_load_dwordx4 v10, s[24:27], s48 offen lds
    s_mov_b32 m0, 1024
    s_mov_b32 s48, 1056768
    buffer_load_dwordx4 v10, s[24:27], s48 offen lds
    s_mov_b32 m0, 2048
    s_mov_b32 s48, 1064960
    buffer_load_dwordx4 v10, s[24:27], s48 offen lds
    s_mov_b32 m0, 3072
    s_mov_b32 s48, 1073152
    buffer_load_dwordx4 v10, s[24:27], s48 offen lds
    s_mov_b32 m0, 4096
    s_mov_b32 s48, 1081344
    buffer_load_dwordx4 v10, s[24:27], s48 offen lds
    s_mov_b32 m0, 5120
    s_mov_b32 s48, 1089536
    buffer_load_dwordx4 v10, s[24:27], s48 offen lds
    s_mov_b32 m0, 6144
    s_mov_b32 s48, 1097728
    buffer_load_dwordx4 v10, s[24:27], s48 offen lds
    s_mov_b32 m0, 7168
    s_mov_b32 s48, 1105920
    buffer_load_dwordx4 v10, s[24:27], s48 offen lds
    s_mov_b32 m0, 8192
    s_mov_b32 s48, 1114112
    buffer_load_dwordx4 v10, s[24:27], s48 offen lds
    s_mov_b32 m0, 9216
    s_mov_b32 s48, 1122304
    buffer_load_dwordx4 v10, s[24:27], s48 offen lds
    s_mov_b32 m0, 10240
    s_mov_b32 s48, 1130496
    buffer_load_dwordx4 v10, s[24:27], s48 offen lds
    s_mov_b32 m0, 11264
    s_mov_b32 s48, 1138688
    buffer_load_dwordx4 v10, s[24:27], s48 offen lds
    s_mov_b32 m0, 12288
    s_mov_b32 s48, 1146880
    buffer_load_dwordx4 v10, s[24:27], s48 offen lds
    s_mov_b32 m0, 13312
    s_mov_b32 s48, 1155072
    buffer_load_dwordx4 v10, s[24:27], s48 offen lds
    s_mov_b32 m0, 14336
    s_mov_b32 s48, 1163264
    buffer_load_dwordx4 v10, s[24:27], s48 offen lds
    s_mov_b32 m0, 15360
    s_mov_b32 s48, 1171456
    buffer_load_dwordx4 v10, s[24:27], s48 offen lds
    s_waitcnt vmcnt(32)
    s_barrier
    s_mov_b32 m0, 16384
    s_mov_b32 s48, 1179648
    buffer_load_dwordx4 v10, s[24:27], s48 offen lds
    s_mov_b32 m0, 17408
    s_mov_b32 s48, 1187840
    buffer_load_dwordx4 v10, s[24:27], s48 offen lds
    s_mov_b32 m0, 18432
    s_mov_b32 s48, 1196032
    buffer_load_dwordx4 v10, s[24:27], s48 offen lds
    s_mov_b32 m0, 19456
    s_mov_b32 s48, 1204224
    buffer_load_dwordx4 v10, s[24:27], s48 offen lds
    s_mov_b32 m0, 20480
    s_mov_b32 s48, 1212416
    buffer_load_dwordx4 v10, s[24:27], s48 offen lds
    s_mov_b32 m0, 21504
    s_mov_b32 s48, 1220608
    buffer_load_dwordx4 v10, s[24:27], s48 offen lds
    s_mov_b32 m0, 22528
    s_mov_b32 s48, 1228800
    buffer_load_dwordx4 v10, s[24:27], s48 offen lds
    s_mov_b32 m0, 23552
    s_mov_b32 s48, 1236992
    buffer_load_dwordx4 v10, s[24:27], s48 offen lds
    s_mov_b32 m0, 24576
    s_mov_b32 s48, 1245184
    buffer_load_dwordx4 v10, s[24:27], s48 offen lds
    s_mov_b32 m0, 25600
    s_mov_b32 s48, 1253376
    buffer_load_dwordx4 v10, s[24:27], s48 offen lds
    s_mov_b32 m0, 26624
    s_mov_b32 s48, 1261568
    buffer_load_dwordx4 v10, s[24:27], s48 offen lds
    s_mov_b32 m0, 27648
    s_mov_b32 s48, 1269760
    buffer_load_dwordx4 v10, s[24:27], s48 offen lds
    s_mov_b32 m0, 28672
    s_mov_b32 s48, 1277952
    buffer_load_dwordx4 v10, s[24:27], s48 offen lds
    s_mov_b32 m0, 29696
    s_mov_b32 s48, 1286144
    buffer_load_dwordx4 v10, s[24:27], s48 offen lds
    s_mov_b32 m0, 30720
    s_mov_b32 s48, 1294336
    buffer_load_dwordx4 v10, s[24:27], s48 offen lds
    s_mov_b32 m0, 31744
    s_mov_b32 s48, 1302528
    buffer_load_dwordx4 v10, s[24:27], s48 offen lds
    s_waitcnt vmcnt(32)
    s_barrier
    s_mov_b32 m0, 32768
    s_mov_b32 s48, 1310720
    buffer_load_dwordx4 v10, s[24:27], s48 offen lds
    s_mov_b32 m0, 33792
    s_mov_b32 s48, 1318912
    buffer_load_dwordx4 v10, s[24:27], s48 offen lds
    s_mov_b32 m0, 34816
    s_mov_b32 s48, 1327104
    buffer_load_dwordx4 v10, s[24:27], s48 offen lds
    s_mov_b32 m0, 35840
    s_mov_b32 s48, 1335296
    buffer_load_dwordx4 v10, s[24:27], s48 offen lds
    s_mov_b32 m0, 36864
    s_mov_b32 s48, 1343488
    buffer_load_dwordx4 v10, s[24:27], s48 offen lds
    s_mov_b32 m0, 37888
    s_mov_b32 s48, 1351680
    buffer_load_dwordx4 v10, s[24:27], s48 offen lds
    s_mov_b32 m0, 38912
    s_mov_b32 s48, 1359872
    buffer_load_dwordx4 v10, s[24:27], s48 offen lds
    s_mov_b32 m0, 39936
    s_mov_b32 s48, 1368064
    buffer_load_dwordx4 v10, s[24:27], s48 offen lds
    s_mov_b32 m0, 40960
    s_mov_b32 s48, 1376256
    buffer_load_dwordx4 v10, s[24:27], s48 offen lds
    s_mov_b32 m0, 41984
    s_mov_b32 s48, 1384448
    buffer_load_dwordx4 v10, s[24:27], s48 offen lds
    s_mov_b32 m0, 43008
    s_mov_b32 s48, 1392640
    buffer_load_dwordx4 v10, s[24:27], s48 offen lds
    s_mov_b32 m0, 44032
    s_mov_b32 s48, 1400832
    buffer_load_dwordx4 v10, s[24:27], s48 offen lds
    s_mov_b32 m0, 45056
    s_mov_b32 s48, 1409024
    buffer_load_dwordx4 v10, s[24:27], s48 offen lds
    s_mov_b32 m0, 46080
    s_mov_b32 s48, 1417216
    buffer_load_dwordx4 v10, s[24:27], s48 offen lds
    s_mov_b32 m0, 47104
    s_mov_b32 s48, 1425408
    buffer_load_dwordx4 v10, s[24:27], s48 offen lds
    s_mov_b32 m0, 48128
    s_mov_b32 s48, 1433600
    buffer_load_dwordx4 v10, s[24:27], s48 offen lds
    s_waitcnt vmcnt(32)
    s_barrier
    s_mov_b32 m0, 49152
    s_mov_b32 s48, 1441792
    buffer_load_dwordx4 v10, s[24:27], s48 offen lds
    s_mov_b32 m0, 50176
    s_mov_b32 s48, 1449984
    buffer_load_dwordx4 v10, s[24:27], s48 offen lds
    s_mov_b32 m0, 51200
    s_mov_b32 s48, 1458176
    buffer_load_dwordx4 v10, s[24:27], s48 offen lds
    s_mov_b32 m0, 52224
    s_mov_b32 s48, 1466368
    buffer_load_dwordx4 v10, s[24:27], s48 offen lds
    s_mov_b32 m0, 53248
    s_mov_b32 s48, 1474560
    buffer_load_dwordx4 v10, s[24:27], s48 offen lds
    s_mov_b32 m0, 54272
    s_mov_b32 s48, 1482752
    buffer_load_dwordx4 v10, s[24:27], s48 offen lds
    s_mov_b32 m0, 55296
    s_mov_b32 s48, 1490944
    buffer_load_dwordx4 v10, s[24:27], s48 offen lds
    s_mov_b32 m0, 56320
    s_mov_b32 s48, 1499136
    buffer_load_dwordx4 v10, s[24:27], s48 offen lds
    s_mov_b32 m0, 57344
    s_mov_b32 s48, 1507328
    buffer_load_dwordx4 v10, s[24:27], s48 offen lds
    s_mov_b32 m0, 58368
    s_mov_b32 s48, 1515520
    buffer_load_dwordx4 v10, s[24:27], s48 offen lds
    s_mov_b32 m0, 59392
    s_mov_b32 s48, 1523712
    buffer_load_dwordx4 v10, s[24:27], s48 offen lds
    s_mov_b32 m0, 60416
    s_mov_b32 s48, 1531904
    buffer_load_dwordx4 v10, s[24:27], s48 offen lds
    s_mov_b32 m0, 61440
    s_mov_b32 s48, 1540096
    buffer_load_dwordx4 v10, s[24:27], s48 offen lds
    s_mov_b32 m0, 62464
    s_mov_b32 s48, 1548288
    buffer_load_dwordx4 v10, s[24:27], s48 offen lds
    s_mov_b32 m0, 63488
    s_mov_b32 s48, 1556480
    buffer_load_dwordx4 v10, s[24:27], s48 offen lds
    s_mov_b32 m0, 64512
    s_mov_b32 s48, 1564672
    buffer_load_dwordx4 v10, s[24:27], s48 offen lds
    s_waitcnt vmcnt(32)
    s_barrier
    s_mov_b32 m0, 0
    s_mov_b32 s48, 1572864
    buffer_load_dwordx4 v10, s[24:27], s48 offen lds
    s_mov_b32 m0, 1024
    s_mov_b32 s48, 1581056
    buffer_load_dwordx4 v10, s[24:27], s48 offen lds
    s_mov_b32 m0, 2048
    s_mov_b32 s48, 1589248
    buffer_load_dwordx4 v10, s[24:27], s48 offen lds
    s_mov_b32 m0, 3072
    s_mov_b32 s48, 1597440
    buffer_load_dwordx4 v10, s[24:27], s48 offen lds
    s_mov_b32 m0, 4096
    s_mov_b32 s48, 1605632
    buffer_load_dwordx4 v10, s[24:27], s48 offen lds
    s_mov_b32 m0, 5120
    s_mov_b32 s48, 1613824
    buffer_load_dwordx4 v10, s[24:27], s48 offen lds
    s_mov_b32 m0, 6144
    s_mov_b32 s48, 1622016
    buffer_load_dwordx4 v10, s[24:27], s48 offen lds
    s_mov_b32 m0, 7168
    s_mov_b32 s48, 1630208
    buffer_load_dwordx4 v10, s[24:27], s48 offen lds
    s_mov_b32 m0, 8192
    s_mov_b32 s48, 1638400
    buffer_load_dwordx4 v10, s[24:27], s48 offen lds
    s_mov_b32 m0, 9216
    s_mov_b32 s48, 1646592
    buffer_load_dwordx4 v10, s[24:27], s48 offen lds
    s_mov_b32 m0, 10240
    s_mov_b32 s48, 1654784
    buffer_load_dwordx4 v10, s[24:27], s48 offen lds
    s_mov_b32 m0, 11264
    s_mov_b32 s48, 1662976
    buffer_load_dwordx4 v10, s[24:27], s48 offen lds
    s_mov_b32 m0, 12288
    s_mov_b32 s48, 1671168
    buffer_load_dwordx4 v10, s[24:27], s48 offen lds
    s_mov_b32 m0, 13312
    s_mov_b32 s48, 1679360
    buffer_load_dwordx4 v10, s[24:27], s48 offen lds
    s_mov_b32 m0, 14336
    s_mov_b32 s48, 1687552
    buffer_load_dwordx4 v10, s[24:27], s48 offen lds
    s_mov_b32 m0, 15360
    s_mov_b32 s48, 1695744
    buffer_load_dwordx4 v10, s[24:27], s48 offen lds
    s_waitcnt vmcnt(32)
    s_barrier
    s_mov_b32 m0, 16384
    s_mov_b32 s48, 1703936
    buffer_load_dwordx4 v10, s[24:27], s48 offen lds
    s_mov_b32 m0, 17408
    s_mov_b32 s48, 1712128
    buffer_load_dwordx4 v10, s[24:27], s48 offen lds
    s_mov_b32 m0, 18432
    s_mov_b32 s48, 1720320
    buffer_load_dwordx4 v10, s[24:27], s48 offen lds
    s_mov_b32 m0, 19456
    s_mov_b32 s48, 1728512
    buffer_load_dwordx4 v10, s[24:27], s48 offen lds
    s_mov_b32 m0, 20480
    s_mov_b32 s48, 1736704
    buffer_load_dwordx4 v10, s[24:27], s48 offen lds
    s_mov_b32 m0, 21504
    s_mov_b32 s48, 1744896
    buffer_load_dwordx4 v10, s[24:27], s48 offen lds
    s_mov_b32 m0, 22528
    s_mov_b32 s48, 1753088
    buffer_load_dwordx4 v10, s[24:27], s48 offen lds
    s_mov_b32 m0, 23552
    s_mov_b32 s48, 1761280
    buffer_load_dwordx4 v10, s[24:27], s48 offen lds
    s_mov_b32 m0, 24576
    s_mov_b32 s48, 1769472
    buffer_load_dwordx4 v10, s[24:27], s48 offen lds
    s_mov_b32 m0, 25600
    s_mov_b32 s48, 1777664
    buffer_load_dwordx4 v10, s[24:27], s48 offen lds
    s_mov_b32 m0, 26624
    s_mov_b32 s48, 1785856
    buffer_load_dwordx4 v10, s[24:27], s48 offen lds
    s_mov_b32 m0, 27648
    s_mov_b32 s48, 1794048
    buffer_load_dwordx4 v10, s[24:27], s48 offen lds
    s_mov_b32 m0, 28672
    s_mov_b32 s48, 1802240
    buffer_load_dwordx4 v10, s[24:27], s48 offen lds
    s_mov_b32 m0, 29696
    s_mov_b32 s48, 1810432
    buffer_load_dwordx4 v10, s[24:27], s48 offen lds
    s_mov_b32 m0, 30720
    s_mov_b32 s48, 1818624
    buffer_load_dwordx4 v10, s[24:27], s48 offen lds
    s_mov_b32 m0, 31744
    s_mov_b32 s48, 1826816
    buffer_load_dwordx4 v10, s[24:27], s48 offen lds
    s_waitcnt vmcnt(32)
    s_barrier
    s_mov_b32 m0, 32768
    s_mov_b32 s48, 1835008
    buffer_load_dwordx4 v10, s[24:27], s48 offen lds
    s_mov_b32 m0, 33792
    s_mov_b32 s48, 1843200
    buffer_load_dwordx4 v10, s[24:27], s48 offen lds
    s_mov_b32 m0, 34816
    s_mov_b32 s48, 1851392
    buffer_load_dwordx4 v10, s[24:27], s48 offen lds
    s_mov_b32 m0, 35840
    s_mov_b32 s48, 1859584
    buffer_load_dwordx4 v10, s[24:27], s48 offen lds
    s_mov_b32 m0, 36864
    s_mov_b32 s48, 1867776
    buffer_load_dwordx4 v10, s[24:27], s48 offen lds
    s_mov_b32 m0, 37888
    s_mov_b32 s48, 1875968
    buffer_load_dwordx4 v10, s[24:27], s48 offen lds
    s_mov_b32 m0, 38912
    s_mov_b32 s48, 1884160
    buffer_load_dwordx4 v10, s[24:27], s48 offen lds
    s_mov_b32 m0, 39936
    s_mov_b32 s48, 1892352
    buffer_load_dwordx4 v10, s[24:27], s48 offen lds
    s_mov_b32 m0, 40960
    s_mov_b32 s48, 1900544
    buffer_load_dwordx4 v10, s[24:27], s48 offen lds
    s_mov_b32 m0, 41984
    s_mov_b32 s48, 1908736
    buffer_load_dwordx4 v10, s[24:27], s48 offen lds
    s_mov_b32 m0, 43008
    s_mov_b32 s48, 1916928
    buffer_load_dwordx4 v10, s[24:27], s48 offen lds
    s_mov_b32 m0, 44032
    s_mov_b32 s48, 1925120
    buffer_load_dwordx4 v10, s[24:27], s48 offen lds
    s_mov_b32 m0, 45056
    s_mov_b32 s48, 1933312
    buffer_load_dwordx4 v10, s[24:27], s48 offen lds
    s_mov_b32 m0, 46080
    s_mov_b32 s48, 1941504
    buffer_load_dwordx4 v10, s[24:27], s48 offen lds
    s_mov_b32 m0, 47104
    s_mov_b32 s48, 1949696
    buffer_load_dwordx4 v10, s[24:27], s48 offen lds
    s_mov_b32 m0, 48128
    s_mov_b32 s48, 1957888
    buffer_load_dwordx4 v10, s[24:27], s48 offen lds
    s_waitcnt vmcnt(32)
    s_barrier
    s_mov_b32 m0, 49152
    s_mov_b32 s48, 1966080
    buffer_load_dwordx4 v10, s[24:27], s48 offen lds
    s_mov_b32 m0, 50176
    s_mov_b32 s48, 1974272
    buffer_load_dwordx4 v10, s[24:27], s48 offen lds
    s_mov_b32 m0, 51200
    s_mov_b32 s48, 1982464
    buffer_load_dwordx4 v10, s[24:27], s48 offen lds
    s_mov_b32 m0, 52224
    s_mov_b32 s48, 1990656
    buffer_load_dwordx4 v10, s[24:27], s48 offen lds
    s_mov_b32 m0, 53248
    s_mov_b32 s48, 1998848
    buffer_load_dwordx4 v10, s[24:27], s48 offen lds
    s_mov_b32 m0, 54272
    s_mov_b32 s48, 2007040
    buffer_load_dwordx4 v10, s[24:27], s48 offen lds
    s_mov_b32 m0, 55296
    s_mov_b32 s48, 2015232
    buffer_load_dwordx4 v10, s[24:27], s48 offen lds
    s_mov_b32 m0, 56320
    s_mov_b32 s48, 2023424
    buffer_load_dwordx4 v10, s[24:27], s48 offen lds
    s_mov_b32 m0, 57344
    s_mov_b32 s48, 2031616
    buffer_load_dwordx4 v10, s[24:27], s48 offen lds
    s_mov_b32 m0, 58368
    s_mov_b32 s48, 2039808
    buffer_load_dwordx4 v10, s[24:27], s48 offen lds
    s_mov_b32 m0, 59392
    s_mov_b32 s48, 2048000
    buffer_load_dwordx4 v10, s[24:27], s48 offen lds
    s_mov_b32 m0, 60416
    s_mov_b32 s48, 2056192
    buffer_load_dwordx4 v10, s[24:27], s48 offen lds
    s_mov_b32 m0, 61440
    s_mov_b32 s48, 2064384
    buffer_load_dwordx4 v10, s[24:27], s48 offen lds
    s_mov_b32 m0, 62464
    s_mov_b32 s48, 2072576
    buffer_load_dwordx4 v10, s[24:27], s48 offen lds
    s_mov_b32 m0, 63488
    s_mov_b32 s48, 2080768
    buffer_load_dwordx4 v10, s[24:27], s48 offen lds
    s_mov_b32 m0, 64512
    s_mov_b32 s48, 2088960
    buffer_load_dwordx4 v10, s[24:27], s48 offen lds
    s_waitcnt vmcnt(32)
    s_barrier
    s_mov_b32 m0, 0
    s_mov_b32 s48, 2097152
    buffer_load_dwordx4 v10, s[24:27], s48 offen lds
    s_mov_b32 m0, 1024
    s_mov_b32 s48, 2105344
    buffer_load_dwordx4 v10, s[24:27], s48 offen lds
    s_mov_b32 m0, 2048
    s_mov_b32 s48, 2113536
    buffer_load_dwordx4 v10, s[24:27], s48 offen lds
    s_mov_b32 m0, 3072
    s_mov_b32 s48, 2121728
    buffer_load_dwordx4 v10, s[24:27], s48 offen lds
    s_mov_b32 m0, 4096
    s_mov_b32 s48, 2129920
    buffer_load_dwordx4 v10, s[24:27], s48 offen lds
    s_mov_b32 m0, 5120
    s_mov_b32 s48, 2138112
    buffer_load_dwordx4 v10, s[24:27], s48 offen lds
    s_mov_b32 m0, 6144
    s_mov_b32 s48, 2146304
    buffer_load_dwordx4 v10, s[24:27], s48 offen lds
    s_mov_b32 m0, 7168
    s_mov_b32 s48, 2154496
    buffer_load_dwordx4 v10, s[24:27], s48 offen lds
    s_mov_b32 m0, 8192
    s_mov_b32 s48, 2162688
    buffer_load_dwordx4 v10, s[24:27], s48 offen lds
    s_mov_b32 m0, 9216
    s_mov_b32 s48, 2170880
    buffer_load_dwordx4 v10, s[24:27], s48 offen lds
    s_mov_b32 m0, 10240
    s_mov_b32 s48, 2179072
    buffer_load_dwordx4 v10, s[24:27], s48 offen lds
    s_mov_b32 m0, 11264
    s_mov_b32 s48, 2187264
    buffer_load_dwordx4 v10, s[24:27], s48 offen lds
    s_mov_b32 m0, 12288
    s_mov_b32 s48, 2195456
    buffer_load_dwordx4 v10, s[24:27], s48 offen lds
    s_mov_b32 m0, 13312
    s_mov_b32 s48, 2203648
    buffer_load_dwordx4 v10, s[24:27], s48 offen lds
    s_mov_b32 m0, 14336
    s_mov_b32 s48, 2211840
    buffer_load_dwordx4 v10, s[24:27], s48 offen lds
    s_mov_b32 m0, 15360
    s_mov_b32 s48, 2220032
    buffer_load_dwordx4 v10, s[24:27], s48 offen lds
    s_waitcnt vmcnt(32)
    s_barrier
    s_mov_b32 m0, 16384
    s_mov_b32 s48, 2228224
    buffer_load_dwordx4 v10, s[24:27], s48 offen lds
    s_mov_b32 m0, 17408
    s_mov_b32 s48, 2236416
    buffer_load_dwordx4 v10, s[24:27], s48 offen lds
    s_mov_b32 m0, 18432
    s_mov_b32 s48, 2244608
    buffer_load_dwordx4 v10, s[24:27], s48 offen lds
    s_mov_b32 m0, 19456
    s_mov_b32 s48, 2252800
    buffer_load_dwordx4 v10, s[24:27], s48 offen lds
    s_mov_b32 m0, 20480
    s_mov_b32 s48, 2260992
    buffer_load_dwordx4 v10, s[24:27], s48 offen lds
    s_mov_b32 m0, 21504
    s_mov_b32 s48, 2269184
    buffer_load_dwordx4 v10, s[24:27], s48 offen lds
    s_mov_b32 m0, 22528
    s_mov_b32 s48, 2277376
    buffer_load_dwordx4 v10, s[24:27], s48 offen lds
    s_mov_b32 m0, 23552
    s_mov_b32 s48, 2285568
    buffer_load_dwordx4 v10, s[24:27], s48 offen lds
    s_mov_b32 m0, 24576
    s_mov_b32 s48, 2293760
    buffer_load_dwordx4 v10, s[24:27], s48 offen lds
    s_mov_b32 m0, 25600
    s_mov_b32 s48, 2301952
    buffer_load_dwordx4 v10, s[24:27], s48 offen lds
    s_mov_b32 m0, 26624
    s_mov_b32 s48, 2310144
    buffer_load_dwordx4 v10, s[24:27], s48 offen lds
    s_mov_b32 m0, 27648
    s_mov_b32 s48, 2318336
    buffer_load_dwordx4 v10, s[24:27], s48 offen lds
    s_mov_b32 m0, 28672
    s_mov_b32 s48, 2326528
    buffer_load_dwordx4 v10, s[24:27], s48 offen lds
    s_mov_b32 m0, 29696
    s_mov_b32 s48, 2334720
    buffer_load_dwordx4 v10, s[24:27], s48 offen lds
    s_mov_b32 m0, 30720
    s_mov_b32 s48, 2342912
    buffer_load_dwordx4 v10, s[24:27], s48 offen lds
    s_mov_b32 m0, 31744
    s_mov_b32 s48, 2351104
    buffer_load_dwordx4 v10, s[24:27], s48 offen lds
    s_waitcnt vmcnt(32)
    s_barrier
    s_mov_b32 m0, 32768
    s_mov_b32 s48, 2359296
    buffer_load_dwordx4 v10, s[24:27], s48 offen lds
    s_mov_b32 m0, 33792
    s_mov_b32 s48, 2367488
    buffer_load_dwordx4 v10, s[24:27], s48 offen lds
    s_mov_b32 m0, 34816
    s_mov_b32 s48, 2375680
    buffer_load_dwordx4 v10, s[24:27], s48 offen lds
    s_mov_b32 m0, 35840
    s_mov_b32 s48, 2383872
    buffer_load_dwordx4 v10, s[24:27], s48 offen lds
    s_mov_b32 m0, 36864
    s_mov_b32 s48, 2392064
    buffer_load_dwordx4 v10, s[24:27], s48 offen lds
    s_mov_b32 m0, 37888
    s_mov_b32 s48, 2400256
    buffer_load_dwordx4 v10, s[24:27], s48 offen lds
    s_mov_b32 m0, 38912
    s_mov_b32 s48, 2408448
    buffer_load_dwordx4 v10, s[24:27], s48 offen lds
    s_mov_b32 m0, 39936
    s_mov_b32 s48, 2416640
    buffer_load_dwordx4 v10, s[24:27], s48 offen lds
    s_mov_b32 m0, 40960
    s_mov_b32 s48, 2424832
    buffer_load_dwordx4 v10, s[24:27], s48 offen lds
    s_mov_b32 m0, 41984
    s_mov_b32 s48, 2433024
    buffer_load_dwordx4 v10, s[24:27], s48 offen lds
    s_mov_b32 m0, 43008
    s_mov_b32 s48, 2441216
    buffer_load_dwordx4 v10, s[24:27], s48 offen lds
    s_mov_b32 m0, 44032
    s_mov_b32 s48, 2449408
    buffer_load_dwordx4 v10, s[24:27], s48 offen lds
    s_mov_b32 m0, 45056
    s_mov_b32 s48, 2457600
    buffer_load_dwordx4 v10, s[24:27], s48 offen lds
    s_mov_b32 m0, 46080
    s_mov_b32 s48, 2465792
    buffer_load_dwordx4 v10, s[24:27], s48 offen lds
    s_mov_b32 m0, 47104
    s_mov_b32 s48, 2473984
    buffer_load_dwordx4 v10, s[24:27], s48 offen lds
    s_mov_b32 m0, 48128
    s_mov_b32 s48, 2482176
    buffer_load_dwordx4 v10, s[24:27], s48 offen lds
    s_waitcnt vmcnt(32)
    s_barrier
    s_mov_b32 m0, 49152
    s_mov_b32 s48, 2490368
    buffer_load_dwordx4 v10, s[24:27], s48 offen lds
    s_mov_b32 m0, 50176
    s_mov_b32 s48, 2498560
    buffer_load_dwordx4 v10, s[24:27], s48 offen lds
    s_mov_b32 m0, 51200
    s_mov_b32 s48, 2506752
    buffer_load_dwordx4 v10, s[24:27], s48 offen lds
    s_mov_b32 m0, 52224
    s_mov_b32 s48, 2514944
    buffer_load_dwordx4 v10, s[24:27], s48 offen lds
    s_mov_b32 m0, 53248
    s_mov_b32 s48, 2523136
    buffer_load_dwordx4 v10, s[24:27], s48 offen lds
    s_mov_b32 m0, 54272
    s_mov_b32 s48, 2531328
    buffer_load_dwordx4 v10, s[24:27], s48 offen lds
    s_mov_b32 m0, 55296
    s_mov_b32 s48, 2539520
    buffer_load_dwordx4 v10, s[24:27], s48 offen lds
    s_mov_b32 m0, 56320
    s_mov_b32 s48, 2547712
    buffer_load_dwordx4 v10, s[24:27], s48 offen lds
    s_mov_b32 m0, 57344
    s_mov_b32 s48, 2555904
    buffer_load_dwordx4 v10, s[24:27], s48 offen lds
    s_mov_b32 m0, 58368
    s_mov_b32 s48, 2564096
    buffer_load_dwordx4 v10, s[24:27], s48 offen lds
    s_mov_b32 m0, 59392
    s_mov_b32 s48, 2572288
    buffer_load_dwordx4 v10, s[24:27], s48 offen lds
    s_mov_b32 m0, 60416
    s_mov_b32 s48, 2580480
    buffer_load_dwordx4 v10, s[24:27], s48 offen lds
    s_mov_b32 m0, 61440
    s_mov_b32 s48, 2588672
    buffer_load_dwordx4 v10, s[24:27], s48 offen lds
    s_mov_b32 m0, 62464
    s_mov_b32 s48, 2596864
    buffer_load_dwordx4 v10, s[24:27], s48 offen lds
    s_mov_b32 m0, 63488
    s_mov_b32 s48, 2605056
    buffer_load_dwordx4 v10, s[24:27], s48 offen lds
    s_mov_b32 m0, 64512
    s_mov_b32 s48, 2613248
    buffer_load_dwordx4 v10, s[24:27], s48 offen lds
    s_waitcnt vmcnt(32)
    s_barrier
    s_mov_b32 m0, 0
    s_mov_b32 s48, 2621440
    buffer_load_dwordx4 v10, s[24:27], s48 offen lds
    s_mov_b32 m0, 1024
    s_mov_b32 s48, 2629632
    buffer_load_dwordx4 v10, s[24:27], s48 offen lds
    s_mov_b32 m0, 2048
    s_mov_b32 s48, 2637824
    buffer_load_dwordx4 v10, s[24:27], s48 offen lds
    s_mov_b32 m0, 3072
    s_mov_b32 s48, 2646016
    buffer_load_dwordx4 v10, s[24:27], s48 offen lds
    s_mov_b32 m0, 4096
    s_mov_b32 s48, 2654208
    buffer_load_dwordx4 v10, s[24:27], s48 offen lds
    s_mov_b32 m0, 5120
    s_mov_b32 s48, 2662400
    buffer_load_dwordx4 v10, s[24:27], s48 offen lds
    s_mov_b32 m0, 6144
    s_mov_b32 s48, 2670592
    buffer_load_dwordx4 v10, s[24:27], s48 offen lds
    s_mov_b32 m0, 7168
    s_mov_b32 s48, 2678784
    buffer_load_dwordx4 v10, s[24:27], s48 offen lds
    s_mov_b32 m0, 8192
    s_mov_b32 s48, 2686976
    buffer_load_dwordx4 v10, s[24:27], s48 offen lds
    s_mov_b32 m0, 9216
    s_mov_b32 s48, 2695168
    buffer_load_dwordx4 v10, s[24:27], s48 offen lds
    s_mov_b32 m0, 10240
    s_mov_b32 s48, 2703360
    buffer_load_dwordx4 v10, s[24:27], s48 offen lds
    s_mov_b32 m0, 11264
    s_mov_b32 s48, 2711552
    buffer_load_dwordx4 v10, s[24:27], s48 offen lds
    s_mov_b32 m0, 12288
    s_mov_b32 s48, 2719744
    buffer_load_dwordx4 v10, s[24:27], s48 offen lds
    s_mov_b32 m0, 13312
    s_mov_b32 s48, 2727936
    buffer_load_dwordx4 v10, s[24:27], s48 offen lds
    s_mov_b32 m0, 14336
    s_mov_b32 s48, 2736128
    buffer_load_dwordx4 v10, s[24:27], s48 offen lds
    s_mov_b32 m0, 15360
    s_mov_b32 s48, 2744320
    buffer_load_dwordx4 v10, s[24:27], s48 offen lds
    s_waitcnt vmcnt(32)
    s_barrier
    s_mov_b32 m0, 16384
    s_mov_b32 s48, 2752512
    buffer_load_dwordx4 v10, s[24:27], s48 offen lds
    s_mov_b32 m0, 17408
    s_mov_b32 s48, 2760704
    buffer_load_dwordx4 v10, s[24:27], s48 offen lds
    s_mov_b32 m0, 18432
    s_mov_b32 s48, 2768896
    buffer_load_dwordx4 v10, s[24:27], s48 offen lds
    s_mov_b32 m0, 19456
    s_mov_b32 s48, 2777088
    buffer_load_dwordx4 v10, s[24:27], s48 offen lds
    s_mov_b32 m0, 20480
    s_mov_b32 s48, 2785280
    buffer_load_dwordx4 v10, s[24:27], s48 offen lds
    s_mov_b32 m0, 21504
    s_mov_b32 s48, 2793472
    buffer_load_dwordx4 v10, s[24:27], s48 offen lds
    s_mov_b32 m0, 22528
    s_mov_b32 s48, 2801664
    buffer_load_dwordx4 v10, s[24:27], s48 offen lds
    s_mov_b32 m0, 23552
    s_mov_b32 s48, 2809856
    buffer_load_dwordx4 v10, s[24:27], s48 offen lds
    s_mov_b32 m0, 24576
    s_mov_b32 s48, 2818048
    buffer_load_dwordx4 v10, s[24:27], s48 offen lds
    s_mov_b32 m0, 25600
    s_mov_b32 s48, 2826240
    buffer_load_dwordx4 v10, s[24:27], s48 offen lds
    s_mov_b32 m0, 26624
    s_mov_b32 s48, 2834432
    buffer_load_dwordx4 v10, s[24:27], s48 offen lds
    s_mov_b32 m0, 27648
    s_mov_b32 s48, 2842624
    buffer_load_dwordx4 v10, s[24:27], s48 offen lds
    s_mov_b32 m0, 28672
    s_mov_b32 s48, 2850816
    buffer_load_dwordx4 v10, s[24:27], s48 offen lds
    s_mov_b32 m0, 29696
    s_mov_b32 s48, 2859008
    buffer_load_dwordx4 v10, s[24:27], s48 offen lds
    s_mov_b32 m0, 30720
    s_mov_b32 s48, 2867200
    buffer_load_dwordx4 v10, s[24:27], s48 offen lds
    s_mov_b32 m0, 31744
    s_mov_b32 s48, 2875392
    buffer_load_dwordx4 v10, s[24:27], s48 offen lds
    s_waitcnt vmcnt(32)
    s_barrier
    s_mov_b32 m0, 32768
    s_mov_b32 s48, 2883584
    buffer_load_dwordx4 v10, s[24:27], s48 offen lds
    s_mov_b32 m0, 33792
    s_mov_b32 s48, 2891776
    buffer_load_dwordx4 v10, s[24:27], s48 offen lds
    s_mov_b32 m0, 34816
    s_mov_b32 s48, 2899968
    buffer_load_dwordx4 v10, s[24:27], s48 offen lds
    s_mov_b32 m0, 35840
    s_mov_b32 s48, 2908160
    buffer_load_dwordx4 v10, s[24:27], s48 offen lds
    s_mov_b32 m0, 36864
    s_mov_b32 s48, 2916352
    buffer_load_dwordx4 v10, s[24:27], s48 offen lds
    s_mov_b32 m0, 37888
    s_mov_b32 s48, 2924544
    buffer_load_dwordx4 v10, s[24:27], s48 offen lds
    s_mov_b32 m0, 38912
    s_mov_b32 s48, 2932736
    buffer_load_dwordx4 v10, s[24:27], s48 offen lds
    s_mov_b32 m0, 39936
    s_mov_b32 s48, 2940928
    buffer_load_dwordx4 v10, s[24:27], s48 offen lds
    s_mov_b32 m0, 40960
    s_mov_b32 s48, 2949120
    buffer_load_dwordx4 v10, s[24:27], s48 offen lds
    s_mov_b32 m0, 41984
    s_mov_b32 s48, 2957312
    buffer_load_dwordx4 v10, s[24:27], s48 offen lds
    s_mov_b32 m0, 43008
    s_mov_b32 s48, 2965504
    buffer_load_dwordx4 v10, s[24:27], s48 offen lds
    s_mov_b32 m0, 44032
    s_mov_b32 s48, 2973696
    buffer_load_dwordx4 v10, s[24:27], s48 offen lds
    s_mov_b32 m0, 45056
    s_mov_b32 s48, 2981888
    buffer_load_dwordx4 v10, s[24:27], s48 offen lds
    s_mov_b32 m0, 46080
    s_mov_b32 s48, 2990080
    buffer_load_dwordx4 v10, s[24:27], s48 offen lds
    s_mov_b32 m0, 47104
    s_mov_b32 s48, 2998272
    buffer_load_dwordx4 v10, s[24:27], s48 offen lds
    s_mov_b32 m0, 48128
    s_mov_b32 s48, 3006464
    buffer_load_dwordx4 v10, s[24:27], s48 offen lds
    s_waitcnt vmcnt(32)
    s_barrier
    s_mov_b32 m0, 49152
    s_mov_b32 s48, 3014656
    buffer_load_dwordx4 v10, s[24:27], s48 offen lds
    s_mov_b32 m0, 50176
    s_mov_b32 s48, 3022848
    buffer_load_dwordx4 v10, s[24:27], s48 offen lds
    s_mov_b32 m0, 51200
    s_mov_b32 s48, 3031040
    buffer_load_dwordx4 v10, s[24:27], s48 offen lds
    s_mov_b32 m0, 52224
    s_mov_b32 s48, 3039232
    buffer_load_dwordx4 v10, s[24:27], s48 offen lds
    s_mov_b32 m0, 53248
    s_mov_b32 s48, 3047424
    buffer_load_dwordx4 v10, s[24:27], s48 offen lds
    s_mov_b32 m0, 54272
    s_mov_b32 s48, 3055616
    buffer_load_dwordx4 v10, s[24:27], s48 offen lds
    s_mov_b32 m0, 55296
    s_mov_b32 s48, 3063808
    buffer_load_dwordx4 v10, s[24:27], s48 offen lds
    s_mov_b32 m0, 56320
    s_mov_b32 s48, 3072000
    buffer_load_dwordx4 v10, s[24:27], s48 offen lds
    s_mov_b32 m0, 57344
    s_mov_b32 s48, 3080192
    buffer_load_dwordx4 v10, s[24:27], s48 offen lds
    s_mov_b32 m0, 58368
    s_mov_b32 s48, 3088384
    buffer_load_dwordx4 v10, s[24:27], s48 offen lds
    s_mov_b32 m0, 59392
    s_mov_b32 s48, 3096576
    buffer_load_dwordx4 v10, s[24:27], s48 offen lds
    s_mov_b32 m0, 60416
    s_mov_b32 s48, 3104768
    buffer_load_dwordx4 v10, s[24:27], s48 offen lds
    s_mov_b32 m0, 61440
    s_mov_b32 s48, 3112960
    buffer_load_dwordx4 v10, s[24:27], s48 offen lds
    s_mov_b32 m0, 62464
    s_mov_b32 s48, 3121152
    buffer_load_dwordx4 v10, s[24:27], s48 offen lds
    s_mov_b32 m0, 63488
    s_mov_b32 s48, 3129344
    buffer_load_dwordx4 v10, s[24:27], s48 offen lds
    s_mov_b32 m0, 64512
    s_mov_b32 s48, 3137536
    buffer_load_dwordx4 v10, s[24:27], s48 offen lds
    s_waitcnt vmcnt(32)
    s_barrier
    s_mov_b32 m0, 0
    s_mov_b32 s48, 3145728
    buffer_load_dwordx4 v10, s[24:27], s48 offen lds
    s_mov_b32 m0, 1024
    s_mov_b32 s48, 3153920
    buffer_load_dwordx4 v10, s[24:27], s48 offen lds
    s_mov_b32 m0, 2048
    s_mov_b32 s48, 3162112
    buffer_load_dwordx4 v10, s[24:27], s48 offen lds
    s_mov_b32 m0, 3072
    s_mov_b32 s48, 3170304
    buffer_load_dwordx4 v10, s[24:27], s48 offen lds
    s_mov_b32 m0, 4096
    s_mov_b32 s48, 3178496
    buffer_load_dwordx4 v10, s[24:27], s48 offen lds
    s_mov_b32 m0, 5120
    s_mov_b32 s48, 3186688
    buffer_load_dwordx4 v10, s[24:27], s48 offen lds
    s_mov_b32 m0, 6144
    s_mov_b32 s48, 3194880
    buffer_load_dwordx4 v10, s[24:27], s48 offen lds
    s_mov_b32 m0, 7168
    s_mov_b32 s48, 3203072
    buffer_load_dwordx4 v10, s[24:27], s48 offen lds
    s_mov_b32 m0, 8192
    s_mov_b32 s48, 3211264
    buffer_load_dwordx4 v10, s[24:27], s48 offen lds
    s_mov_b32 m0, 9216
    s_mov_b32 s48, 3219456
    buffer_load_dwordx4 v10, s[24:27], s48 offen lds
    s_mov_b32 m0, 10240
    s_mov_b32 s48, 3227648
    buffer_load_dwordx4 v10, s[24:27], s48 offen lds
    s_mov_b32 m0, 11264
    s_mov_b32 s48, 3235840
    buffer_load_dwordx4 v10, s[24:27], s48 offen lds
    s_mov_b32 m0, 12288
    s_mov_b32 s48, 3244032
    buffer_load_dwordx4 v10, s[24:27], s48 offen lds
    s_mov_b32 m0, 13312
    s_mov_b32 s48, 3252224
    buffer_load_dwordx4 v10, s[24:27], s48 offen lds
    s_mov_b32 m0, 14336
    s_mov_b32 s48, 3260416
    buffer_load_dwordx4 v10, s[24:27], s48 offen lds
    s_mov_b32 m0, 15360
    s_mov_b32 s48, 3268608
    buffer_load_dwordx4 v10, s[24:27], s48 offen lds
    s_waitcnt vmcnt(32)
    s_barrier
    s_mov_b32 m0, 16384
    s_mov_b32 s48, 3276800
    buffer_load_dwordx4 v10, s[24:27], s48 offen lds
    s_mov_b32 m0, 17408
    s_mov_b32 s48, 3284992
    buffer_load_dwordx4 v10, s[24:27], s48 offen lds
    s_mov_b32 m0, 18432
    s_mov_b32 s48, 3293184
    buffer_load_dwordx4 v10, s[24:27], s48 offen lds
    s_mov_b32 m0, 19456
    s_mov_b32 s48, 3301376
    buffer_load_dwordx4 v10, s[24:27], s48 offen lds
    s_mov_b32 m0, 20480
    s_mov_b32 s48, 3309568
    buffer_load_dwordx4 v10, s[24:27], s48 offen lds
    s_mov_b32 m0, 21504
    s_mov_b32 s48, 3317760
    buffer_load_dwordx4 v10, s[24:27], s48 offen lds
    s_mov_b32 m0, 22528
    s_mov_b32 s48, 3325952
    buffer_load_dwordx4 v10, s[24:27], s48 offen lds
    s_mov_b32 m0, 23552
    s_mov_b32 s48, 3334144
    buffer_load_dwordx4 v10, s[24:27], s48 offen lds
    s_mov_b32 m0, 24576
    s_mov_b32 s48, 3342336
    buffer_load_dwordx4 v10, s[24:27], s48 offen lds
    s_mov_b32 m0, 25600
    s_mov_b32 s48, 3350528
    buffer_load_dwordx4 v10, s[24:27], s48 offen lds
    s_mov_b32 m0, 26624
    s_mov_b32 s48, 3358720
    buffer_load_dwordx4 v10, s[24:27], s48 offen lds
    s_mov_b32 m0, 27648
    s_mov_b32 s48, 3366912
    buffer_load_dwordx4 v10, s[24:27], s48 offen lds
    s_mov_b32 m0, 28672
    s_mov_b32 s48, 3375104
    buffer_load_dwordx4 v10, s[24:27], s48 offen lds
    s_mov_b32 m0, 29696
    s_mov_b32 s48, 3383296
    buffer_load_dwordx4 v10, s[24:27], s48 offen lds
    s_mov_b32 m0, 30720
    s_mov_b32 s48, 3391488
    buffer_load_dwordx4 v10, s[24:27], s48 offen lds
    s_mov_b32 m0, 31744
    s_mov_b32 s48, 3399680
    buffer_load_dwordx4 v10, s[24:27], s48 offen lds
    s_waitcnt vmcnt(32)
    s_barrier
    s_mov_b32 m0, 32768
    s_mov_b32 s48, 3407872
    buffer_load_dwordx4 v10, s[24:27], s48 offen lds
    s_mov_b32 m0, 33792
    s_mov_b32 s48, 3416064
    buffer_load_dwordx4 v10, s[24:27], s48 offen lds
    s_mov_b32 m0, 34816
    s_mov_b32 s48, 3424256
    buffer_load_dwordx4 v10, s[24:27], s48 offen lds
    s_mov_b32 m0, 35840
    s_mov_b32 s48, 3432448
    buffer_load_dwordx4 v10, s[24:27], s48 offen lds
    s_mov_b32 m0, 36864
    s_mov_b32 s48, 3440640
    buffer_load_dwordx4 v10, s[24:27], s48 offen lds
    s_mov_b32 m0, 37888
    s_mov_b32 s48, 3448832
    buffer_load_dwordx4 v10, s[24:27], s48 offen lds
    s_mov_b32 m0, 38912
    s_mov_b32 s48, 3457024
    buffer_load_dwordx4 v10, s[24:27], s48 offen lds
    s_mov_b32 m0, 39936
    s_mov_b32 s48, 3465216
    buffer_load_dwordx4 v10, s[24:27], s48 offen lds
    s_mov_b32 m0, 40960
    s_mov_b32 s48, 3473408
    buffer_load_dwordx4 v10, s[24:27], s48 offen lds
    s_mov_b32 m0, 41984
    s_mov_b32 s48, 3481600
    buffer_load_dwordx4 v10, s[24:27], s48 offen lds
    s_mov_b32 m0, 43008
    s_mov_b32 s48, 3489792
    buffer_load_dwordx4 v10, s[24:27], s48 offen lds
    s_mov_b32 m0, 44032
    s_mov_b32 s48, 3497984
    buffer_load_dwordx4 v10, s[24:27], s48 offen lds
    s_mov_b32 m0, 45056
    s_mov_b32 s48, 3506176
    buffer_load_dwordx4 v10, s[24:27], s48 offen lds
    s_mov_b32 m0, 46080
    s_mov_b32 s48, 3514368
    buffer_load_dwordx4 v10, s[24:27], s48 offen lds
    s_mov_b32 m0, 47104
    s_mov_b32 s48, 3522560
    buffer_load_dwordx4 v10, s[24:27], s48 offen lds
    s_mov_b32 m0, 48128
    s_mov_b32 s48, 3530752
    buffer_load_dwordx4 v10, s[24:27], s48 offen lds
    s_waitcnt vmcnt(32)
    s_barrier
    s_mov_b32 m0, 49152
    s_mov_b32 s48, 3538944
    buffer_load_dwordx4 v10, s[24:27], s48 offen lds
    s_mov_b32 m0, 50176
    s_mov_b32 s48, 3547136
    buffer_load_dwordx4 v10, s[24:27], s48 offen lds
    s_mov_b32 m0, 51200
    s_mov_b32 s48, 3555328
    buffer_load_dwordx4 v10, s[24:27], s48 offen lds
    s_mov_b32 m0, 52224
    s_mov_b32 s48, 3563520
    buffer_load_dwordx4 v10, s[24:27], s48 offen lds
    s_mov_b32 m0, 53248
    s_mov_b32 s48, 3571712
    buffer_load_dwordx4 v10, s[24:27], s48 offen lds
    s_mov_b32 m0, 54272
    s_mov_b32 s48, 3579904
    buffer_load_dwordx4 v10, s[24:27], s48 offen lds
    s_mov_b32 m0, 55296
    s_mov_b32 s48, 3588096
    buffer_load_dwordx4 v10, s[24:27], s48 offen lds
    s_mov_b32 m0, 56320
    s_mov_b32 s48, 3596288
    buffer_load_dwordx4 v10, s[24:27], s48 offen lds
    s_mov_b32 m0, 57344
    s_mov_b32 s48, 3604480
    buffer_load_dwordx4 v10, s[24:27], s48 offen lds
    s_mov_b32 m0, 58368
    s_mov_b32 s48, 3612672
    buffer_load_dwordx4 v10, s[24:27], s48 offen lds
    s_mov_b32 m0, 59392
    s_mov_b32 s48, 3620864
    buffer_load_dwordx4 v10, s[24:27], s48 offen lds
    s_mov_b32 m0, 60416
    s_mov_b32 s48, 3629056
    buffer_load_dwordx4 v10, s[24:27], s48 offen lds
    s_mov_b32 m0, 61440
    s_mov_b32 s48, 3637248
    buffer_load_dwordx4 v10, s[24:27], s48 offen lds
    s_mov_b32 m0, 62464
    s_mov_b32 s48, 3645440
    buffer_load_dwordx4 v10, s[24:27], s48 offen lds
    s_mov_b32 m0, 63488
    s_mov_b32 s48, 3653632
    buffer_load_dwordx4 v10, s[24:27], s48 offen lds
    s_mov_b32 m0, 64512
    s_mov_b32 s48, 3661824
    buffer_load_dwordx4 v10, s[24:27], s48 offen lds
    s_waitcnt vmcnt(32)
    s_barrier
    s_mov_b32 m0, 0
    s_mov_b32 s48, 3670016
    buffer_load_dwordx4 v10, s[24:27], s48 offen lds
    s_mov_b32 m0, 1024
    s_mov_b32 s48, 3678208
    buffer_load_dwordx4 v10, s[24:27], s48 offen lds
    s_mov_b32 m0, 2048
    s_mov_b32 s48, 3686400
    buffer_load_dwordx4 v10, s[24:27], s48 offen lds
    s_mov_b32 m0, 3072
    s_mov_b32 s48, 3694592
    buffer_load_dwordx4 v10, s[24:27], s48 offen lds
    s_mov_b32 m0, 4096
    s_mov_b32 s48, 3702784
    buffer_load_dwordx4 v10, s[24:27], s48 offen lds
    s_mov_b32 m0, 5120
    s_mov_b32 s48, 3710976
    buffer_load_dwordx4 v10, s[24:27], s48 offen lds
    s_mov_b32 m0, 6144
    s_mov_b32 s48, 3719168
    buffer_load_dwordx4 v10, s[24:27], s48 offen lds
    s_mov_b32 m0, 7168
    s_mov_b32 s48, 3727360
    buffer_load_dwordx4 v10, s[24:27], s48 offen lds
    s_mov_b32 m0, 8192
    s_mov_b32 s48, 3735552
    buffer_load_dwordx4 v10, s[24:27], s48 offen lds
    s_mov_b32 m0, 9216
    s_mov_b32 s48, 3743744
    buffer_load_dwordx4 v10, s[24:27], s48 offen lds
    s_mov_b32 m0, 10240
    s_mov_b32 s48, 3751936
    buffer_load_dwordx4 v10, s[24:27], s48 offen lds
    s_mov_b32 m0, 11264
    s_mov_b32 s48, 3760128
    buffer_load_dwordx4 v10, s[24:27], s48 offen lds
    s_mov_b32 m0, 12288
    s_mov_b32 s48, 3768320
    buffer_load_dwordx4 v10, s[24:27], s48 offen lds
    s_mov_b32 m0, 13312
    s_mov_b32 s48, 3776512
    buffer_load_dwordx4 v10, s[24:27], s48 offen lds
    s_mov_b32 m0, 14336
    s_mov_b32 s48, 3784704
    buffer_load_dwordx4 v10, s[24:27], s48 offen lds
    s_mov_b32 m0, 15360
    s_mov_b32 s48, 3792896
    buffer_load_dwordx4 v10, s[24:27], s48 offen lds
    s_waitcnt vmcnt(32)
    s_barrier
    s_mov_b32 m0, 16384
    s_mov_b32 s48, 3801088
    buffer_load_dwordx4 v10, s[24:27], s48 offen lds
    s_mov_b32 m0, 17408
    s_mov_b32 s48, 3809280
    buffer_load_dwordx4 v10, s[24:27], s48 offen lds
    s_mov_b32 m0, 18432
    s_mov_b32 s48, 3817472
    buffer_load_dwordx4 v10, s[24:27], s48 offen lds
    s_mov_b32 m0, 19456
    s_mov_b32 s48, 3825664
    buffer_load_dwordx4 v10, s[24:27], s48 offen lds
    s_mov_b32 m0, 20480
    s_mov_b32 s48, 3833856
    buffer_load_dwordx4 v10, s[24:27], s48 offen lds
    s_mov_b32 m0, 21504
    s_mov_b32 s48, 3842048
    buffer_load_dwordx4 v10, s[24:27], s48 offen lds
    s_mov_b32 m0, 22528
    s_mov_b32 s48, 3850240
    buffer_load_dwordx4 v10, s[24:27], s48 offen lds
    s_mov_b32 m0, 23552
    s_mov_b32 s48, 3858432
    buffer_load_dwordx4 v10, s[24:27], s48 offen lds
    s_mov_b32 m0, 24576
    s_mov_b32 s48, 3866624
    buffer_load_dwordx4 v10, s[24:27], s48 offen lds
    s_mov_b32 m0, 25600
    s_mov_b32 s48, 3874816
    buffer_load_dwordx4 v10, s[24:27], s48 offen lds
    s_mov_b32 m0, 26624
    s_mov_b32 s48, 3883008
    buffer_load_dwordx4 v10, s[24:27], s48 offen lds
    s_mov_b32 m0, 27648
    s_mov_b32 s48, 3891200
    buffer_load_dwordx4 v10, s[24:27], s48 offen lds
    s_mov_b32 m0, 28672
    s_mov_b32 s48, 3899392
    buffer_load_dwordx4 v10, s[24:27], s48 offen lds
    s_mov_b32 m0, 29696
    s_mov_b32 s48, 3907584
    buffer_load_dwordx4 v10, s[24:27], s48 offen lds
    s_mov_b32 m0, 30720
    s_mov_b32 s48, 3915776
    buffer_load_dwordx4 v10, s[24:27], s48 offen lds
    s_mov_b32 m0, 31744
    s_mov_b32 s48, 3923968
    buffer_load_dwordx4 v10, s[24:27], s48 offen lds
    s_waitcnt vmcnt(32)
    s_barrier
    s_mov_b32 m0, 32768
    s_mov_b32 s48, 3932160
    buffer_load_dwordx4 v10, s[24:27], s48 offen lds
    s_mov_b32 m0, 33792
    s_mov_b32 s48, 3940352
    buffer_load_dwordx4 v10, s[24:27], s48 offen lds
    s_mov_b32 m0, 34816
    s_mov_b32 s48, 3948544
    buffer_load_dwordx4 v10, s[24:27], s48 offen lds
    s_mov_b32 m0, 35840
    s_mov_b32 s48, 3956736
    buffer_load_dwordx4 v10, s[24:27], s48 offen lds
    s_mov_b32 m0, 36864
    s_mov_b32 s48, 3964928
    buffer_load_dwordx4 v10, s[24:27], s48 offen lds
    s_mov_b32 m0, 37888
    s_mov_b32 s48, 3973120
    buffer_load_dwordx4 v10, s[24:27], s48 offen lds
    s_mov_b32 m0, 38912
    s_mov_b32 s48, 3981312
    buffer_load_dwordx4 v10, s[24:27], s48 offen lds
    s_mov_b32 m0, 39936
    s_mov_b32 s48, 3989504
    buffer_load_dwordx4 v10, s[24:27], s48 offen lds
    s_mov_b32 m0, 40960
    s_mov_b32 s48, 3997696
    buffer_load_dwordx4 v10, s[24:27], s48 offen lds
    s_mov_b32 m0, 41984
    s_mov_b32 s48, 4005888
    buffer_load_dwordx4 v10, s[24:27], s48 offen lds
    s_mov_b32 m0, 43008
    s_mov_b32 s48, 4014080
    buffer_load_dwordx4 v10, s[24:27], s48 offen lds
    s_mov_b32 m0, 44032
    s_mov_b32 s48, 4022272
    buffer_load_dwordx4 v10, s[24:27], s48 offen lds
    s_mov_b32 m0, 45056
    s_mov_b32 s48, 4030464
    buffer_load_dwordx4 v10, s[24:27], s48 offen lds
    s_mov_b32 m0, 46080
    s_mov_b32 s48, 4038656
    buffer_load_dwordx4 v10, s[24:27], s48 offen lds
    s_mov_b32 m0, 47104
    s_mov_b32 s48, 4046848
    buffer_load_dwordx4 v10, s[24:27], s48 offen lds
    s_mov_b32 m0, 48128
    s_mov_b32 s48, 4055040
    buffer_load_dwordx4 v10, s[24:27], s48 offen lds
    s_waitcnt vmcnt(32)
    s_barrier
    s_mov_b32 m0, 49152
    s_mov_b32 s48, 4063232
    buffer_load_dwordx4 v10, s[24:27], s48 offen lds
    s_mov_b32 m0, 50176
    s_mov_b32 s48, 4071424
    buffer_load_dwordx4 v10, s[24:27], s48 offen lds
    s_mov_b32 m0, 51200
    s_mov_b32 s48, 4079616
    buffer_load_dwordx4 v10, s[24:27], s48 offen lds
    s_mov_b32 m0, 52224
    s_mov_b32 s48, 4087808
    buffer_load_dwordx4 v10, s[24:27], s48 offen lds
    s_mov_b32 m0, 53248
    s_mov_b32 s48, 4096000
    buffer_load_dwordx4 v10, s[24:27], s48 offen lds
    s_mov_b32 m0, 54272
    s_mov_b32 s48, 4104192
    buffer_load_dwordx4 v10, s[24:27], s48 offen lds
    s_mov_b32 m0, 55296
    s_mov_b32 s48, 4112384
    buffer_load_dwordx4 v10, s[24:27], s48 offen lds
    s_mov_b32 m0, 56320
    s_mov_b32 s48, 4120576
    buffer_load_dwordx4 v10, s[24:27], s48 offen lds
    s_mov_b32 m0, 57344
    s_mov_b32 s48, 4128768
    buffer_load_dwordx4 v10, s[24:27], s48 offen lds
    s_mov_b32 m0, 58368
    s_mov_b32 s48, 4136960
    buffer_load_dwordx4 v10, s[24:27], s48 offen lds
    s_mov_b32 m0, 59392
    s_mov_b32 s48, 4145152
    buffer_load_dwordx4 v10, s[24:27], s48 offen lds
    s_mov_b32 m0, 60416
    s_mov_b32 s48, 4153344
    buffer_load_dwordx4 v10, s[24:27], s48 offen lds
    s_mov_b32 m0, 61440
    s_mov_b32 s48, 4161536
    buffer_load_dwordx4 v10, s[24:27], s48 offen lds
    s_mov_b32 m0, 62464
    s_mov_b32 s48, 4169728
    buffer_load_dwordx4 v10, s[24:27], s48 offen lds
    s_mov_b32 m0, 63488
    s_mov_b32 s48, 4177920
    buffer_load_dwordx4 v10, s[24:27], s48 offen lds
    s_mov_b32 m0, 64512
    s_mov_b32 s48, 4186112
    buffer_load_dwordx4 v10, s[24:27], s48 offen lds
    s_waitcnt vmcnt(32)
    s_barrier
    s_waitcnt vmcnt(16)
    s_barrier
    s_waitcnt vmcnt(0)
    s_barrier
K2_END:
    s_endpgm
.section .rodata,"a"
.p2align 6
.amdhsa_kernel mha_attn_kernel
  .amdhsa_next_free_vgpr 256
  .amdhsa_next_free_sgpr 102
  .amdhsa_accum_offset 256
  .amdhsa_group_segment_fixed_size 0
  .amdhsa_kernarg_size 64
  .amdhsa_user_sgpr_count 2
  .amdhsa_user_sgpr_kernarg_segment_ptr 1
  .amdhsa_system_sgpr_workgroup_id_x 1
.end_amdhsa_kernel
.p2align 6
.amdhsa_kernel mha_oproj_kernel
  .amdhsa_next_free_vgpr 256
  .amdhsa_next_free_sgpr 102
  .amdhsa_accum_offset 256
  .amdhsa_group_segment_fixed_size 0
  .amdhsa_kernarg_size 64
  .amdhsa_user_sgpr_count 2
  .amdhsa_user_sgpr_kernarg_segment_ptr 1
  .amdhsa_system_sgpr_workgroup_id_x 1
.end_amdhsa_kernel
```
